```python
import torch

def _softmax(x, axis=-1):
    return torch.softmax(x, dim=axis)
def _gelu(x):
    return torch.nn.functional.gelu(x, approximate="tanh")
def _silu(x):
    return torch.nn.functional.silu(x)
def _sigmoid(x):
    return torch.sigmoid(x)
def _layernorm(x, axis=-1, eps=1e-5):
    m = x.mean(dim=axis, keepdim=True)
    v = x.var(dim=axis, keepdim=True, unbiased=False)
    return (x - m) / torch.sqrt(v + eps)
def _scatter_add(tgt, idx, src, axis=0):
    return tgt.clone().index_add_(axis, idx, src)
def _segment_sum(src, seg, n):
    out = torch.zeros((n,) + src.shape[1:], dtype=src.dtype)
    return out.index_add_(0, seg, src)
def _pad(x, pw):
    flat = tuple(v for pair in reversed(pw) for v in pair)
    return torch.nn.functional.pad(x, flat)

kernel_name = 'gated_mix__compressed_kv_cla__swiglu_ffn__decode'

def setup_inputs():

    _w = (lambda a: (lambda t: t.to(torch.bfloat16) if t.is_floating_point() else t)(torch.as_tensor(a)))
    def _A_setup():
        B, H, Sq, Sk, D, M = 4, 32, 1, 4096, 128, 512
        Dc = 4 * D
        return {
            "x": _w((lambda *s: torch.randn(*s, dtype=torch.bfloat16) * 0.05)(B, Sq, M)),
            "c_kv": _w((lambda *s: torch.randn(*s, dtype=torch.bfloat16) * 0.8)(B, Sk, Dc)),
            "w_q": _w((lambda *s: torch.randn(*s, dtype=torch.bfloat16) * 6.4)(M, H, D) * (M ** -0.5)),
            "w_uk": _w((lambda *s: torch.randn(*s, dtype=torch.bfloat16) * 6.4)(Dc, H, D) * (Dc ** -0.5)),
            "w_uv": _w((lambda *s: torch.randn(*s, dtype=torch.bfloat16) * 0.8)(Dc, H, D) * (Dc ** -0.5)),
            "w_o": _w((lambda *s: torch.randn(*s, dtype=torch.bfloat16) * 0.8)(H, D, M) * ((H * D) ** -0.5)),
        }
    _A_in = _A_setup()

    def _B_setup():
        B, S, D, F = 4, 1, 512, 1792
        return {
            "x": _w((lambda *s: torch.randn(*s, dtype=torch.bfloat16) * 0.05)(B, S, D)),
            "w_gate": _w((lambda *s: torch.randn(*s, dtype=torch.bfloat16) * 0.1)(D, F)),
            "w_up": _w((lambda *s: torch.randn(*s, dtype=torch.bfloat16) * 0.1)(D, F)),
            "w_down": _w((lambda *s: torch.randn(*s, dtype=torch.bfloat16) * 0.1)(F, D)),
        }
    _B_in = _B_setup()

    return {
        "A_x": _A_in["x"],
        "A_c_kv": _A_in["c_kv"],
        "A_w_q": _A_in["w_q"],
        "A_w_uk": _A_in["w_uk"],
        "A_w_uv": _A_in["w_uv"],
        "A_w_o": _A_in["w_o"],
        "B_x": _B_in["x"],
        "B_w_gate": _B_in["w_gate"],
        "B_w_up": _B_in["w_up"],
        "B_w_down": _B_in["w_down"],
        "gate_w": _w((lambda *s: torch.randn(*s, dtype=torch.bfloat16) * 0.05)(512) * 16.0),
    }

def reference(A_x, A_c_kv, A_w_q, A_w_uk, A_w_uv, A_w_o, B_x, B_w_gate, B_w_up, B_w_down, gate_w):
    def _A_ref(x, c_kv, w_q, w_uk, w_uv, w_o):
        B, Sq, M = x.shape[0], x.shape[1], x.shape[2]
        Sk = c_kv.shape[1]
        H, D = w_q.shape[1], w_q.shape[2]
        q = torch.einsum("bqm,mhd->bhqd", x, w_q)
        k = torch.einsum("bkc,chd->bhkd", c_kv, w_uk)
        v = torch.einsum("bkc,chd->bhkd", c_kv, w_uv)
        scores = torch.einsum("bhqd,bhkd->bhqk", q, k) * (D ** -0.5)
        off = Sk - Sq
        qi = torch.arange(Sq)[:, None]
        kj = torch.arange(Sk)[None, :]
        cmask = kj <= (qi + off)
        scores = torch.where(cmask[None, None], scores, -1e9)
        p = _softmax(scores, axis=-1)
        ctx = torch.einsum("bhqk,bhkd->bhqd", p, v)
        return torch.einsum("bhqd,hdm->bqm", ctx, w_o)

    def _B_ref(x, w_gate, w_up, w_down):
        g = _silu(x @ w_gate)
        u = x @ w_up
        return (g * u) @ w_down

    x = A_x
    g = _sigmoid((x * gate_w).sum(-1, keepdims=True))
    a = _A_ref(x, A_c_kv, A_w_q, A_w_uk, A_w_uv, A_w_o)
    b = _B_ref(x, B_w_gate, B_w_up, B_w_down)
    return g * a + (1 - g) * b
```

```asm
; @launch grid=(256,1,1) block=(512,1,1) lds=163840
.amdgcn_target "amdgcn-amd-amdhsa--gfx950"
.text
.globl gated_mix__compressed_kv_cla__swiglu_ffn__decode_kernel
.p2align 12
.p2align 8
.type gated_mix__compressed_kv_cla__swiglu_ffn__decode_kernel,@function
gated_mix__compressed_kv_cla__swiglu_ffn__decode_kernel:
    s_cmp_ge_u32 s2, 256
    s_cbranch_scc1 Lend
    s_load_dwordx16 s[8:23], s[0:1], 0
    s_load_dwordx8 s[24:31], s[0:1], 64
    s_load_dwordx4 s[32:35], s[0:1], 96
    s_cmp_lt_u32 s2, 128
    s_cbranch_scc1 Lnopf
    s_getpc_b64 s[62:63]
    v_lshlrev_b32 v2, 7, v0
    v_cmp_gt_u32 vcc, CODE_BYTES-128, v2
    s_and_saveexec_b64 s[60:61], vcc
    s_cbranch_execz Lnopf
    global_load_dword v250, v2, s[62:63]
Lnopf:
    s_mov_b64 exec, -1
    v_lshrrev_b32 v2, 6, v0
    v_and_b32 v1, 63, v0
    v_readfirstlane_b32 s3, v2
    s_and_b32 s5, s2, 31
    s_bfe_u32 s6, s2, 0x20005
    s_mov_b32 s38, 8257536
    s_mov_b32 s39, 0x20000
    s_mov_b32 s47, 0x20000
    s_lshl_b32 s51, s3, 12
    s_cmp_ge_u32 s2, 128
    s_cbranch_scc1 LA_role
    v_lshrrev_b32 v3, 4, v1
    v_and_b32 v2, 15, v1
    v_lshlrev_b32 v4, 1, v3
    v_xor_b32 v2, v2, v4
    v_lshlrev_b32 v5, 4, v2
    v_lshl_add_u32 v10, v3, 13, v5
    v_xor_b32 v11, 0x80, v10
    v_lshl_add_u32 v2, v3, 10, v5
    s_lshl_b32 s62, s6, 8
    v_add_u32 v242, s62, v2
    v_lshlrev_b32 v16, 4, v1
    s_lshl_b32 s50, s6, 20
    s_lshl_b32 s62, s3, 17
    s_add_u32 s50, s50, s62
    s_lshl_b32 s62, s5, 8
    s_add_u32 s50, s50, s62
    s_add_u32 s52, s50, 31744
    s_add_u32 s53, s50, 63488
    s_add_u32 s54, s50, 95232
    s_add_u32 m0, s51, 65536
    s_mov_b32 s43, 0x20000
    s_mov_b32 s46, 0x400000
    s_lshl_b32 s57, s5, 13
    s_lshl_b32 s62, s3, 10
    s_add_u32 s57, s57, s62
    s_add_u32 s98, s57, 262144
    s_lshl_b32 s62, s6, 8
    s_add_u32 s62, s62, s98
    s_waitcnt lgkmcnt(0)
    s_mov_b32 s44, s12
    s_mov_b32 s45, s13
    s_load_dword s4, s[34:35], 0
    buffer_load_dwordx4 v10, s[44:47], s50 offen offset:0 nt lds
    buffer_load_dwordx4 v11, s[44:47], s52 offen offset:1024 nt lds
    buffer_load_dwordx4 v10, s[44:47], s53 offen offset:2048 nt lds
    buffer_load_dwordx4 v11, s[44:47], s54 offen offset:3072 nt lds
    s_mov_b32 m0, 162816
    s_mov_b32 s36, s34
    s_mov_b32 s37, s35
    s_cmp_lg_u32 s3, 7
    s_cbranch_scc1 Lnox
    global_load_lds_dwordx4 v242, s[8:9]
Lnox:
    s_mov_b64 exec, 0xffff
    buffer_load_dwordx4 v[72:75], v16, s[36:39], s62 offen sc1
    s_mov_b64 exec, -1
    s_mov_b32 m0, s51
    s_mov_b32 s44, s14
    s_mov_b32 s45, s15
    v_lshl_add_u32 v12, v3, 10, v5
    v_xor_b32 v13, 0x80, v12
    v_and_b32 v4, 0x70, v5
    s_movk_i32 s62, 3584
    v_mad_u32_u24 v4, v3, s62, v4
    s_lshl_b32 s62, s6, 3
    s_add_u32 s62, s62, s3
    s_mul_i32 s62, s62, 57344
    s_lshl_b32 s63, s5, 7
    s_add_u32 s62, s62, s63
    v_add_u32 v4, s62, v4
    v_cmp_gt_u32 vcc, 0x80, v5
    v_mov_b32 v5, s22
    v_mov_b32 v6, s23
    v_mov_b32 v7, s24
    v_mov_b32 v2, s25
    v_cndmask_b32 v108, v7, v5, vcc
    v_cndmask_b32 v109, v2, v6, vcc
    v_cndmask_b32 v110, v5, v7, vcc
    v_cndmask_b32 v111, v6, v2, vcc
    v_add_co_u32 v108, vcc, v108, v4
    s_nop 1
    v_addc_co_u32 v109, vcc, 0, v109, vcc
    v_add_u32 v4, 13312, v4
    v_add_co_u32 v110, vcc, v110, v4
    s_nop 1
    v_addc_co_u32 v111, vcc, 0, v111, vcc
    v_add_co_u32 v112, vcc, 26624, v108
    s_nop 1
    v_addc_co_u32 v113, vcc, 0, v109, vcc
    v_add_co_u32 v114, vcc, 26624, v110
    s_nop 1
    v_addc_co_u32 v115, vcc, 0, v111, vcc
    v_bfe_u32 v2, v1, 2, 2
    v_lshrrev_b32 v3, 4, v1
    v_and_b32 v4, 3, v1
    v_lshlrev_b32 v4, 4, v4
    v_lshl_add_u32 v4, v3, 6, v4
    v_lshl_add_u32 v240, v2, 8, v4
    s_lshl_b32 s62, s6, 2
    s_lshl_b32 s48, 0x000f000f, s62
    s_mov_b32 s49, s48
    v_and_b32 v3, 3, v1
    v_lshrrev_b32 v2, 4, v1
    v_lshlrev_b32 v2, 3, v2
    v_lshl_add_u32 v2, v3, 5, v2
    v_lshl_add_u32 v2, v3, 8, v2
    v_add_u32 v242, 162816, v2
    v_lshlrev_b32 v17, 3, v1
    v_add_u32 v17, 147456, v17
    v_and_b32 v2, 15, v1
    v_and_b32 v3, 7, v1
    v_lshlrev_b32 v3, 5, v3
    v_lshl_add_u32 v3, v2, 8, v3
    v_lshrrev_b32 v2, 4, v1
    v_lshl_add_u32 v3, v2, 3, v3
    v_add_u32 v9, s51, v3
    s_lshl_b32 s62, s3, 9
    v_add_u32 v18, s62, v17
    v_and_b32 v3, 3, v1
    v_lshlrev_b32 v2, 3, v2
    v_lshl_add_u32 v2, v3, 8, v2
    s_lshl_b32 s62, s3, 5
    s_add_u32 s62, s62, 159744
    v_add_u32 v8, s62, v2
    v_add_u32 v158, 159744, v16
    v_lshlrev_b32 v157, 2, v1
    v_lshlrev_b32 v147, 12, v1
    v_lshlrev_b32 v156, 10, v1
    v_lshrrev_b32 v2, 4, v1
    v_and_b32 v3, 7, v1
    v_lshlrev_b32 v3, 4, v3
    v_lshl_add_u32 v19, v2, 7, v3
    s_lshl_b32 s59, s5, 2
    s_add_u32 s59, s59, s6
    s_lshl_b32 s59, s59, 11
    s_add_u32 s59, s59, 6815744
    s_lshr_b32 s60, s5, 3
    s_lshl_b32 s60, s60, 10
    s_add_u32 s60, s60, 7864320
    s_and_b32 s61, s5, 7
    s_lshl_b32 s61, s61, 2
    s_add_u32 s61, s61, s6
    s_mov_b32 s58, 0x3e0293ee
    s_lshr_b32 s100, s61, 3
    s_lshl_b32 s100, s100, 7
    s_add_u32 s60, s60, s100
    s_and_b32 s100, s61, 7
    s_add_u32 s60, s60, s100
    s_bfe_u32 s62, s2, 0x20001
    s_lshl_b32 s62, s62, 5
    s_bfe_u32 s63, s2, 0x40003
    s_lshl_b32 s63, s63, 1
    s_add_u32 s62, s62, s63
    s_and_b32 s63, s2, 1
    s_add_u32 s62, s62, s63
    s_lshl_b32 s62, s62, 17
    s_and_b32 s63, s3, 1
    s_lshl_b32 s63, s63, 16
    s_add_u32 s62, s62, s63
    s_lshr_b32 s63, s3, 1
    s_lshl_b32 s63, s63, 2
    s_lshr_b32 s63, 30565, s63
    s_and_b32 s63, s63, 7
    s_lshl_b32 s63, s63, 7
    s_add_u32 s62, s62, s63
    v_add_u32 v146, s62, v156
    s_lshl_b32 s20, s5, 16
    s_lshl_b32 s62, s3, 13
    s_add_u32 s20, s20, s62
    s_lshl_b32 s62, s6, 8
    s_add_u32 s20, s20, s62
    s_add_u32 s21, s20, 3072
    s_mov_b32 s40, s26
    s_mov_b32 s41, s27
    s_mov_b32 s42, 1835008
    v_lshrrev_b32 v2, 2, v1
    v_and_b32 v3, 7, v2
    v_xor_b32 v3, s3, v3
    v_lshlrev_b32 v3, 5, v3
    v_and_b32 v4, 3, v1
    v_lshl_add_u32 v3, v4, 3, v3
    v_lshl_add_u32 v2, v2, 8, v3
    v_add_u32 v14, 65536, v2
    v_lshrrev_b32 v2, 4, v1
    v_bfe_u32 v7, v1, 2, 2
    v_and_b32 v5, 1, v2
    v_lshl_or_b32 v6, v7, 1, v5
    v_xor_b32 v6, s3, v6
    v_lshlrev_b32 v6, 5, v6
    v_lshl_add_u32 v6, v2, 8, v6
    v_lshl_add_u32 v6, v7, 12, v6
    v_lshl_add_u32 v15, v4, 3, v6
    s_and_b32 s62, s3, 3
    s_lshl_b32 s62, s62, 1
    v_or_b32 v5, s62, v5
    v_lshlrev_b32 v5, 1, v5
    v_and_b32 v6, 15, v1
    v_xor_b32 v5, v5, v6
    v_lshlrev_b32 v5, 4, v5
    v_lshl_add_u32 v192, v2, 13, v5
    v_lshlrev_b32 v104, 11, v1
    v_and_b32 v3, 15, v1
    v_lshlrev_b32 v5, 4, v3
    v_lshl_add_u32 v105, v2, 15, v5
    v_lshl_add_u32 v5, v7, 2, v2
    v_lshlrev_b32 v193, 11, v5
    s_and_b32 s62, s3, 3
    s_lshr_b32 s63, s3, 2
    s_lshl_b32 s1, s63, 6
    v_lshl_add_u32 v107, v2, 2, s1
    v_lshrrev_b32 v4, 5, v1
    v_lshlrev_b32 v4, 11, v4
    v_lshl_add_u32 v4, v3, 7, v4
    v_and_b32 v2, 1, v2
    v_lshl_add_u32 v4, v2, 5, v4
    s_lshl_b32 s0, s62, 3
    s_add_u32 s1, s1, s0
    s_add_u32 s1, s1, 151552
    v_add_u32 v106, s1, v4
    s_lshl_b32 s0, s62, 16
    s_add_u32 s0, s0, 6291456
    s_lshl_b32 s1, s63, 15
    s_add_u32 s26, s0, s1
    s_lshl_b32 s1, s6, 7
    s_add_u32 s26, s26, s1
    s_and_b32 s1, s5, 7
    s_lshl_b32 s1, s1, 6
    s_add_u32 s0, s0, s1
    s_lshr_b32 s1, s5, 3
    s_lshl_b32 s1, s1, 4
    s_add_u32 s0, s0, s1
    s_lshl_b32 s96, s62, 20
    s_lshl_b32 s1, s63, 19
    s_add_u32 s96, s96, s1
    s_lshl_b32 s1, s6, 13
    s_add_u32 s96, s96, s1
    s_and_b32 s1, s5, 12
    s_lshl_b32 s1, s1, 3
    s_add_u32 s26, s26, s1
    s_lshl_b32 s1, s1, 3
    s_add_u32 s96, s96, s1
    s_and_b32 s1, s5, 16
    s_add_u32 s26, s26, s1
    s_lshl_b32 s1, s1, 8
    s_add_u32 s96, s96, s1
    s_and_b32 s1, s5, 3
    s_lshl_b32 s1, s1, 2
    s_add_u32 s26, s26, s1
    s_lshl_b32 s1, s1, 8
    s_add_u32 s96, s96, s1
    s_add_u32 s96, s96, 2097152
    s_add_u32 s97, s96, 0x20000
    s_add_u32 s24, s96, 0x60000
    s_lshl_b32 s30, s5, 17
    s_lshl_b32 s62, s6, 8
    s_add_u32 s30, s30, s62
    s_lshl_b32 s62, s3, 14
    s_add_u32 s30, s30, s62
    s_add_u32 s31, s30, 3072
    s_add_u32 s32, s30, 6144
    s_add_u32 s33, s30, 9216
    s_lshl_b32 s7, s6, 15
    s_add_u32 s7, s7, 7995392
    s_and_b32 s62, s5, 7
    s_lshl_b32 s62, s62, 2
    s_lshr_b32 s63, s5, 3
    s_add_u32 s62, s62, s63
    s_lshr_b32 s100, s62, 3
    s_lshl_b32 s100, s100, 7
    s_add_u32 s7, s7, s100
    s_and_b32 s100, s62, 7
    s_add_u32 s7, s7, s100
    s_waitcnt lgkmcnt(0)
    s_mul_i32 s4, s4, 1664525
    s_add_u32 s4, s4, 1013904223
    s_getreg_b32 s62, hwreg(HW_REG_XCC_ID, 0, 4)
    s_lshl_b32 s62, s62, 28
    s_xor_b32 s62, s62, s4
    v_mov_b32 v249, s4
    v_mov_b32 v251, s62
    s_waitcnt vmcnt(1)
    buffer_load_dwordx4 v10, s[44:47], s50 offen offset:0 nt lds
    buffer_load_dwordx4 v11, s[44:47], s52 offen offset:1024 nt lds
    buffer_load_dwordx4 v10, s[44:47], s53 offen offset:2048 nt lds
    buffer_load_dwordx4 v11, s[44:47], s54 offen offset:3072 nt lds
    s_barrier
    ds_read_b64 v[224:225], v242
    ds_read_b64 v[232:233], v242 offset:128
    v_xor_b32 v2, 32, v242
    ds_read_b64 v[226:227], v2
    ds_read_b64 v[234:235], v2 offset:128
    v_xor_b32 v2, 64, v242
    ds_read_b64 v[228:229], v2
    ds_read_b64 v[236:237], v2 offset:128
    v_xor_b32 v2, 96, v242
    ds_read_b64 v[230:231], v2
    ds_read_b64 v[238:239], v2 offset:128
    ds_read_b64_tr_b16 v[36:37], v14 offset:0
    ds_read_b64_tr_b16 v[38:39], v14 offset:4096
    ds_read_b64_tr_b16 v[40:41], v14 offset:8192
    ds_read_b64_tr_b16 v[42:43], v14 offset:12288
    ds_read_b64_tr_b16 v[44:45], v14 offset:16384
    ds_read_b64_tr_b16 v[46:47], v14 offset:20480
    ds_read_b64_tr_b16 v[48:49], v14 offset:24576
    ds_read_b64_tr_b16 v[50:51], v14 offset:28672
    s_waitcnt lgkmcnt(0)
    v_mfma_f32_16x16x32_bf16 v[244:247], v[36:39], v[224:227], 0
    v_mfma_f32_16x16x32_bf16 v[244:247], v[40:43], v[228:231], v[244:247]
    v_mfma_f32_16x16x32_bf16 v[244:247], v[44:47], v[232:235], v[244:247]
    v_mfma_f32_16x16x32_bf16 v[244:247], v[48:51], v[236:239], v[244:247]
    s_nop 7
    v_cvt_pk_bf16_f32 v248, v244, v245
    v_cvt_pk_bf16_f32 v250, v246, v247
    s_mov_b64 exec, s[48:49]
    buffer_store_dwordx4 v[248:251], v240, s[36:39], s98 offen
    s_mov_b64 exec, -1
    s_waitcnt vmcnt(1)
    ds_read_b64 v[52:53], v9
    v_xor_b32 v2, 32, v9
    ds_read_b64 v[54:55], v2
    v_xor_b32 v2, 64, v9
    ds_read_b64 v[56:57], v2
    v_xor_b32 v2, 96, v9
    ds_read_b64 v[58:59], v2
    v_xor_b32 v2, 128, v9
    ds_read_b64 v[60:61], v2
    v_xor_b32 v2, 160, v9
    ds_read_b64 v[62:63], v2
    v_xor_b32 v2, 192, v9
    ds_read_b64 v[64:65], v2
    v_xor_b32 v2, 224, v9
    ds_read_b64 v[66:67], v2
    s_mov_b32 s55, 199999
Lpoll1:
    s_and_b32 s62, s55, 7
    s_cbranch_scc1 Llz3
    s_add_u32 s62, s98, 6815744
    s_mov_b64 exec, s[48:49]
    buffer_store_dwordx4 v[248:251], v240, s[36:39], s62 offen sc1
    s_mov_b64 exec, -1
Llz3:
    s_and_b32 s62, s55, 7
    s_cselect_b32 s62, 0, 6815744
    s_add_u32 s99, s98, s62
    buffer_load_dwordx4 v[72:75], v240, s[36:39], s99 offen offset:0 sc1
    s_waitcnt vmcnt(0)
    v_xor_b32 v2, s4, v73
    v_xor_b32 v3, s4, v75
    v_lshlrev_b32 v3, 4, v3
    v_or_b32 v2, v2, v3
    v_cmp_ne_u32 vcc, 0, v2
    s_cbranch_vccz Ldone2
    s_sleep 1
    s_sub_u32 s55, s55, 1
    s_cbranch_scc0 Lpoll1
Ldone2:
    ds_write2_b32 v18, v72, v74 offset0:0 offset1:1
    v_cmp_ne_u32 vcc, v75, v251
    s_cmp_lg_u64 vcc, 0
    s_cselect_b32 s25, 6815744, 0
    s_cmp_eq_u32 s25, 0
    s_cbranch_scc1 Lng4
    s_add_u32 s62, s98, 6815744
    s_mov_b64 exec, s[48:49]
    buffer_store_dwordx4 v[248:251], v240, s[36:39], s62 offen sc1
    s_mov_b64 exec, -1
Lng4:
    s_waitcnt lgkmcnt(0)
    s_barrier
    ds_read2st64_b64 v[20:23], v17 offset0:0 offset1:1
    ds_read2st64_b64 v[24:27], v17 offset0:2 offset1:3
    ds_read2st64_b64 v[28:31], v17 offset0:4 offset1:5
    ds_read2st64_b64 v[32:35], v17 offset0:6 offset1:7
    s_cmp_lg_u32 s3, 7
    s_cbranch_scc1 Lnh5
    s_mov_b32 exec_hi, 0
    buffer_store_byte v249, v147, s[36:39], s60 offen sc1
    s_mov_b64 exec, -1
Lnh5:
    s_waitcnt lgkmcnt(0)
    v_mfma_f32_16x16x32_bf16 v[244:247], v[52:55], v[20:23], 0
    v_mfma_f32_16x16x32_bf16 v[244:247], v[56:59], v[24:27], v[244:247]
    v_mfma_f32_16x16x32_bf16 v[244:247], v[60:63], v[28:31], v[244:247]
    v_mfma_f32_16x16x32_bf16 v[244:247], v[64:67], v[32:35], v[244:247]
    s_nop 7
    v_add_f32_dpp v244, v244, v244 row_ror:8 row_mask:0xf bank_mask:0xf
    v_add_f32_dpp v245, v245, v245 row_ror:8 row_mask:0xf bank_mask:0xf
    v_add_f32_dpp v246, v246, v246 row_ror:8 row_mask:0xf bank_mask:0xf
    v_add_f32_dpp v247, v247, v247 row_ror:8 row_mask:0xf bank_mask:0xf
    v_add_f32_dpp v244, v244, v244 row_ror:4 row_mask:0xf bank_mask:0xf
    v_add_f32_dpp v245, v245, v245 row_ror:4 row_mask:0xf bank_mask:0xf
    v_add_f32_dpp v246, v246, v246 row_ror:4 row_mask:0xf bank_mask:0xf
    v_add_f32_dpp v247, v247, v247 row_ror:4 row_mask:0xf bank_mask:0xf
    v_mul_f32 v244, s58, v244
    v_mul_f32 v245, s58, v245
    v_mul_f32 v246, s58, v246
    v_mul_f32 v247, s58, v247
    v_cvt_pk_bf16_f32 v72, v244, v245
    v_cvt_pk_bf16_f32 v73, v246, v247
    s_mov_b64 exec, s[48:49]
    ds_write_b64 v8, v[72:73]
    s_mov_b64 exec, -1
    s_lshl_b32 s62, s3, 11
    s_add_u32 m0, s62, 131072
    s_waitcnt lgkmcnt(0)
    s_barrier
    s_cmp_lg_u32 s3, 0
    s_cbranch_scc1 LW_qdone
    ds_read_b128 v[72:75], v158
    s_waitcnt lgkmcnt(0)
    buffer_store_dwordx4 v[72:75], v16, s[36:39], s59 offen sc1
    v_add3_u32 v2, v72, v73, v74
    v_add_u32 v2, v2, v75
    s_nop 1
    v_add_u32_dpp v2, v2, v2 row_ror:8 row_mask:0xf bank_mask:0xf
    s_nop 1
    v_add_u32_dpp v2, v2, v2 row_ror:4 row_mask:0xf bank_mask:0xf
    s_nop 1
    v_add_u32_dpp v2, v2, v2 row_ror:2 row_mask:0xf bank_mask:0xf
    s_nop 1
    v_add_u32_dpp v2, v2, v2 row_ror:1 row_mask:0xf bank_mask:0xf
    v_xor_b32 v2, s4, v2
    buffer_store_dword v2, v157, s[36:39], s59 offen offset:1024 sc1
LW_qdone:
    s_barrier
    s_add_u32 s60, s57, 524288
    s_add_u32 s27, s57, 786432
    s_lshl_b32 s61, s2, 12
    s_lshl_b32 s62, s3, 9
    s_add_u32 s61, s61, s62
    s_add_u32 s61, s61, 1048576
    s_mov_b64 exec, s[48:49]
    buffer_load_dwordx4 v[76:79], v240, s[36:39], s60 offen sc1
    buffer_load_dwordx4 v[80:83], v240, s[36:39], s27 offen sc1
    s_mov_b64 exec, -1
    s_cmp_lg_u32 s3, 7
    s_cbranch_scc1 LW_ngl
    global_load_dwordx4 v[160:163], v16, s[8:9] offset:0
    global_load_dwordx4 v[164:167], v16, s[8:9] offset:1024
    global_load_dwordx4 v[168:171], v16, s[8:9] offset:2048
    global_load_dwordx4 v[172:175], v16, s[8:9] offset:3072
    global_load_dwordx4 v[176:179], v16, s[28:29]
LW_ngl:
    s_cmp_ge_u32 s3, 2
    s_cbranch_scc1 LW_cs1
    global_load_dword v141, v146, s[10:11]
    s_cmp_ge_u32 s3, 2
    s_cbranch_scc1 LW_cs1
    s_waitcnt vmcnt(0)
LW_cs1:
    s_barrier
    s_cmp_lt_u32 s3, 2
    s_cbranch_scc1 LW_ncpf
    s_cmp_ge_u32 s3, 6
    s_cbranch_scc1 LW_ncpf
    global_load_dword v141, v146, s[10:11]
LW_ncpf:
    s_barrier
    s_cmp_ge_u32 s5, 28
    s_cbranch_scc1 LW_nofl
    s_add_u32 m0, s51, 98304
    s_nop 0
    global_load_lds_dwordx4 v[108:109], off offset:0 nt
    global_load_lds_dwordx4 v[110:111], off offset:1024 nt
    global_load_lds_dwordx4 v[112:113], off offset:2048 nt
    global_load_lds_dwordx4 v[114:115], off offset:3072 nt
LW_nofl:
    s_mov_b32 s44, s16
    s_mov_b32 s45, s17
    s_add_u32 m0, s51, 32768
    s_lshl_b32 s62, s3, 11
    s_add_u32 m0, s62, 131072
    s_barrier
    buffer_load_dwordx4 v12, s[40:43], s20 offen nt lds
    buffer_load_dwordx4 v13, s[40:43], s21 offen offset:1024 nt lds
    s_add_u32 m0, s51, 32768
    s_barrier
    buffer_load_dwordx4 v192, s[44:47], s50 offen offset:0 nt lds
    buffer_load_dwordx4 v192, s[44:47], s52 offen offset:1024 nt lds
    buffer_load_dwordx4 v192, s[44:47], s53 offen offset:2048 nt lds
    buffer_load_dwordx4 v192, s[44:47], s54 offen offset:3072 nt lds
    s_branch LW_back
.p2align 12
LW_back:
    s_mov_b64 s[58:59], s[18:19]
    s_add_u32 s16, s57, 786432
    s_add_u32 s17, s16, 4096
    s_add_u32 s98, s96, 0x40000
    v_mov_b32 v249, s4
    v_mov_b32 v251, s4
    s_lshr_b32 s63, s2, 2
    s_lshl_b32 s63, s63, 12
    s_and_b32 s62, s3, 3
    s_lshl_b32 s62, s62, 10
    s_add_u32 s63, s63, s62
    s_add_u32 s63, s63, 8126464
    s_add_u32 s22, s34, s63
    s_addc_u32 s23, s35, 0
    s_and_b32 s28, s4, 0xff
    s_mul_i32 s28, s28, 0x01010101
    s_mov_b32 s29, s28
    s_cmp_lg_u32 s3, 7
    s_cbranch_scc1 LW_nogate
    s_waitcnt vmcnt(10)
    s_cmp_lt_u32 s5, 28
    s_cbranch_scc1 LW_g1
    s_waitcnt vmcnt(6)
LW_g1:
    v_dot2_f32_bf16 v180, v160, v176, 0
    v_dot2_f32_bf16 v181, v164, v176, 0
    v_dot2_f32_bf16 v182, v168, v176, 0
    v_dot2_f32_bf16 v183, v172, v176, 0
    v_dot2_f32_bf16 v180, v161, v177, v180
    v_dot2_f32_bf16 v181, v165, v177, v181
    v_dot2_f32_bf16 v182, v169, v177, v182
    v_dot2_f32_bf16 v183, v173, v177, v183
    v_dot2_f32_bf16 v180, v162, v178, v180
    v_dot2_f32_bf16 v181, v166, v178, v181
    v_dot2_f32_bf16 v182, v170, v178, v182
    v_dot2_f32_bf16 v183, v174, v178, v183
    v_dot2_f32_bf16 v180, v163, v179, v180
    v_dot2_f32_bf16 v181, v167, v179, v181
    v_dot2_f32_bf16 v182, v171, v179, v182
    v_dot2_f32_bf16 v183, v175, v179, v183
    s_nop 2
    v_add_f32_dpp v180, v180, v180 quad_perm:[1,0,3,2] row_mask:0xf bank_mask:0xf
    v_add_f32_dpp v181, v181, v181 quad_perm:[1,0,3,2] row_mask:0xf bank_mask:0xf
    v_add_f32_dpp v182, v182, v182 quad_perm:[1,0,3,2] row_mask:0xf bank_mask:0xf
    v_add_f32_dpp v183, v183, v183 quad_perm:[1,0,3,2] row_mask:0xf bank_mask:0xf
    v_add_f32_dpp v180, v180, v180 quad_perm:[2,3,0,1] row_mask:0xf bank_mask:0xf
    v_add_f32_dpp v181, v181, v181 quad_perm:[2,3,0,1] row_mask:0xf bank_mask:0xf
    v_add_f32_dpp v182, v182, v182 quad_perm:[2,3,0,1] row_mask:0xf bank_mask:0xf
    v_add_f32_dpp v183, v183, v183 quad_perm:[2,3,0,1] row_mask:0xf bank_mask:0xf
    s_mov_b32 vcc_lo, 0xaaaaaaaa
    s_mov_b32 vcc_hi, 0xaaaaaaaa
    s_nop 0
    v_cndmask_b32 v2, v180, v181, vcc
    v_cndmask_b32 v3, v182, v183, vcc
    s_mov_b32 vcc_lo, 0xcccccccc
    s_mov_b32 vcc_hi, 0xcccccccc
    s_nop 0
    v_cndmask_b32 v159, v2, v3, vcc
    s_nop 1
    v_add_f32_dpp v159, v159, v159 row_ror:8 row_mask:0xf bank_mask:0xf
    s_nop 1
    v_add_f32_dpp v159, v159, v159 row_ror:4 row_mask:0xf bank_mask:0xf
    s_nop 1
    v_mov_b32 v2, v159
    s_nop 1
    v_permlane16_swap_b32 v159, v2
    s_nop 1
    v_add_f32 v159, v159, v2
    v_mov_b32 v2, v159
    s_nop 1
    v_permlane32_swap_b32 v159, v2
    s_nop 1
    v_add_f32 v159, v159, v2
    ds_write_b32 v17, v159 offset:0
    s_waitcnt lgkmcnt(0)
LW_nogate:
    s_cmp_ge_u32 s3, 4
    s_cbranch_scc0 LW_nps
    s_waitcnt vmcnt(8)
    s_load_dwordx2 s[8:9], s[22:23], 0 glc
    s_load_dwordx2 s[10:11], s[22:23], 128 glc
    s_load_dwordx2 s[12:13], s[22:23], 256 glc
    s_load_dwordx2 s[14:15], s[22:23], 384 glc
LW_nps:
    s_waitcnt vmcnt(6)
    s_barrier
    ds_read_b64_tr_b16 v[52:53], v14 offset:32768
    ds_read_b64_tr_b16 v[54:55], v14 offset:36864
    ds_read_b64_tr_b16 v[56:57], v14 offset:40960
    ds_read_b64_tr_b16 v[58:59], v14 offset:45056
    ds_read_b64_tr_b16 v[60:61], v14 offset:49152
    ds_read_b64_tr_b16 v[62:63], v14 offset:53248
    ds_read_b64_tr_b16 v[64:65], v14 offset:57344
    ds_read_b64_tr_b16 v[66:67], v14 offset:61440
    v_add_u32 v195, 65536, v14
    ds_read_b32 v159, v17 offset:0
    s_waitcnt lgkmcnt(0)
    v_mfma_f32_16x16x32_bf16 v[244:247], v[52:55], v[224:227], 0
    v_mfma_f32_16x16x32_bf16 v[244:247], v[56:59], v[228:231], v[244:247]
    v_mfma_f32_16x16x32_bf16 v[244:247], v[60:63], v[232:235], v[244:247]
    v_mfma_f32_16x16x32_bf16 v[244:247], v[64:67], v[236:239], v[244:247]
    s_nop 7
    v_cvt_pk_bf16_f32 v248, v244, v245
    v_cvt_pk_bf16_f32 v250, v246, v247
    s_mov_b64 exec, s[48:49]
    buffer_store_dwordx4 v[248:251], v240, s[36:39], s16 offen
    s_mov_b64 exec, -1
    s_cmp_eq_u32 s25, 0
    s_cbranch_scc1 Lng6
    s_add_u32 s62, s16, 6815744
    s_mov_b64 exec, s[48:49]
    buffer_store_dwordx4 v[248:251], v240, s[36:39], s62 offen sc1
    s_mov_b64 exec, -1
Lng6:
    v_mul_f32 v159, 0xbfb8aa3b, v159
    v_exp_f32 v159, v159
    s_nop 0
    v_add_f32 v159, 1.0, v159
    v_rcp_f32 v159, v159
    s_cmp_ge_u32 s3, 4
    s_cbranch_scc0 LW_nmh
    s_mov_b32 s55, 64
Lhint7:
    s_waitcnt lgkmcnt(0)
    s_xor_b64 s[8:9], s[8:9], s[28:29]
    s_xor_b64 s[10:11], s[10:11], s[28:29]
    s_xor_b64 s[12:13], s[12:13], s[28:29]
    s_xor_b64 s[14:15], s[14:15], s[28:29]
    s_or_b64 s[8:9], s[8:9], s[10:11]
    s_or_b64 s[12:13], s[12:13], s[14:15]
    s_or_b64 s[8:9], s[8:9], s[12:13]
    s_cbranch_scc0 Lhintd8
    s_load_dwordx2 s[8:9], s[22:23], 0 glc
    s_load_dwordx2 s[10:11], s[22:23], 128 glc
    s_load_dwordx2 s[12:13], s[22:23], 256 glc
    s_load_dwordx2 s[14:15], s[22:23], 384 glc
    s_sub_u32 s55, s55, 1
    s_cbranch_scc0 Lhint7
    s_waitcnt lgkmcnt(0)
Lhintd8:
    s_sub_u32 s62, 64, s55
    v_mov_b32 v2, s62
    s_and_b32 s62, s3, 3
    s_lshl_b32 s62, s62, 2
    s_add_u32 s62, s62, 159744
    v_mov_b32 v3, s62
    ds_write_b32 v3, v2
    s_waitcnt lgkmcnt(0)
LW_nmh:
    v_mov_b32 v3, 159744
    s_waitcnt vmcnt(1)
    s_barrier
    ds_read_b128 v[4:7], v3
    s_cmp_ge_u32 s3, 4
    s_cbranch_scc1 LW_nf1
    buffer_load_dwordx4 v[124:127], v240, s[36:39], s16 offen sc1
    buffer_load_dwordx4 v[128:131], v240, s[36:39], s17 offen sc1
LW_nf1:
    s_mov_b32 exec_hi, 0
    buffer_load_dwordx4 v[72:75], v104, s[36:39], s0 offen sc1
    s_mov_b64 exec, -1
    s_waitcnt lgkmcnt(0)
    v_or3_b32 v4, v4, v5, v6
    v_or_b32 v4, v4, v7
    v_cmp_ne_u32 vcc, 0, v4
    s_mov_b32 s19, 1
    s_cbranch_vccnz LW_nmf
    buffer_load_dwordx4 v[76:79], v105, s[36:39], s96 offen sc1
    buffer_load_dwordx4 v[80:83], v105, s[36:39], s97 offen sc1
    buffer_load_dwordx4 v[84:87], v105, s[36:39], s98 offen sc1
    buffer_load_dwordx4 v[88:91], v105, s[36:39], s24 offen sc1
    s_mov_b32 exec_lo, 0x11111111
    s_mov_b32 exec_hi, 0x11111111
    buffer_load_dword v194, v193, s[36:39], s26 offen offset:512 sc1
    s_mov_b64 exec, -1
    s_mov_b32 s19, 0
LW_nmf:
    ds_read_b64_tr_b16 v[36:37], v15 offset:32768
    ds_read_b64_tr_b16 v[38:39], v15 offset:33792
    ds_read_b64_tr_b16 v[40:41], v15 offset:34816
    ds_read_b64_tr_b16 v[42:43], v15 offset:35840
    ds_read_b64_tr_b16 v[44:45], v15 offset:49152
    ds_read_b64_tr_b16 v[46:47], v15 offset:50176
    ds_read_b64_tr_b16 v[48:49], v15 offset:51200
    ds_read_b64_tr_b16 v[50:51], v15 offset:52224
    ds_read_b64_tr_b16 v[116:117], v195 offset:0
    ds_read_b64_tr_b16 v[118:119], v195 offset:4096
    ds_read_b64_tr_b16 v[120:121], v195 offset:8192
    ds_read_b64_tr_b16 v[122:123], v195 offset:12288
    s_mov_b64 s[44:45], s[58:59]
    s_add_u32 m0, s51, 65536
    s_mov_b32 s18, 0
    s_cmp_ge_u32 s3, 4
    s_cbranch_scc1 LW_nf2
    s_waitcnt vmcnt(6)
    s_cmp_eq_u32 s19, 0
    s_cbranch_scc1 LW_f6
    s_waitcnt vmcnt(1)
LW_f6:
    v_xor_b32 v2, s4, v125
    v_xor_b32 v3, s4, v127
    v_xor_b32 v4, s4, v129
    v_xor_b32 v5, s4, v131
    v_or3_b32 v2, v2, v4, v5
    v_or_b32 v2, v2, v3
    v_cmp_ne_u32 vcc, 0, v2
    s_mov_b32 s18, 1
    s_cbranch_vccnz LW_nf2
    s_mov_b32 s18, 0
LW_fok:
    v_lshlrev_b32 v132, 16, v124
    v_and_b32 v133, 0xffff0000, v124
    v_lshlrev_b32 v134, 16, v126
    v_and_b32 v135, 0xffff0000, v126
    v_lshlrev_b32 v136, 16, v128
    v_and_b32 v137, 0xffff0000, v128
    v_lshlrev_b32 v138, 16, v130
    v_and_b32 v139, 0xffff0000, v130
    s_nop 1
    v_add_f32_dpp v132, v132, v132 row_ror:8 row_mask:0xf bank_mask:0xf
    v_add_f32_dpp v133, v133, v133 row_ror:8 row_mask:0xf bank_mask:0xf
    v_add_f32_dpp v134, v134, v134 row_ror:8 row_mask:0xf bank_mask:0xf
    v_add_f32_dpp v135, v135, v135 row_ror:8 row_mask:0xf bank_mask:0xf
    v_add_f32_dpp v136, v136, v136 row_ror:8 row_mask:0xf bank_mask:0xf
    v_add_f32_dpp v137, v137, v137 row_ror:8 row_mask:0xf bank_mask:0xf
    v_add_f32_dpp v138, v138, v138 row_ror:8 row_mask:0xf bank_mask:0xf
    v_add_f32_dpp v139, v139, v139 row_ror:8 row_mask:0xf bank_mask:0xf
    v_add_f32_dpp v132, v132, v132 row_ror:4 row_mask:0xf bank_mask:0xf
    v_add_f32_dpp v133, v133, v133 row_ror:4 row_mask:0xf bank_mask:0xf
    v_add_f32_dpp v134, v134, v134 row_ror:4 row_mask:0xf bank_mask:0xf
    v_add_f32_dpp v135, v135, v135 row_ror:4 row_mask:0xf bank_mask:0xf
    v_add_f32_dpp v136, v136, v136 row_ror:4 row_mask:0xf bank_mask:0xf
    v_add_f32_dpp v137, v137, v137 row_ror:4 row_mask:0xf bank_mask:0xf
    v_add_f32_dpp v138, v138, v138 row_ror:4 row_mask:0xf bank_mask:0xf
    v_add_f32_dpp v139, v139, v139 row_ror:4 row_mask:0xf bank_mask:0xf
    v_mul_f32 v2, 0xbfb8aa3b, v132
    v_mul_f32 v3, 0xbfb8aa3b, v133
    v_mul_f32 v4, 0xbfb8aa3b, v134
    v_mul_f32 v5, 0xbfb8aa3b, v135
    v_exp_f32 v2, v2
    v_exp_f32 v3, v3
    v_exp_f32 v4, v4
    v_exp_f32 v5, v5
    v_add_f32 v2, 1.0, v2
    v_add_f32 v3, 1.0, v3
    v_add_f32 v4, 1.0, v4
    v_add_f32 v5, 1.0, v5
    v_rcp_f32 v2, v2
    v_rcp_f32 v3, v3
    v_rcp_f32 v4, v4
    v_rcp_f32 v5, v5
    v_mul_f32 v132, v132, v136
    v_mul_f32 v133, v133, v137
    v_mul_f32 v134, v134, v138
    v_mul_f32 v135, v135, v139
    v_mul_f32 v132, v132, v2
    v_mul_f32 v133, v133, v3
    v_mul_f32 v134, v134, v4
    v_mul_f32 v135, v135, v5
    v_cvt_pk_bf16_f32 v132, v132, v133
    v_cvt_pk_bf16_f32 v133, v134, v135
    ds_write_b64 v18, v[132:133] offset:13312
    s_cmp_lg_u32 s18, 0
    s_cbranch_scc1 LW_fdone
LW_nf2:
    s_cmp_eq_u32 s19, 0
    s_cbranch_scc1 LW_pi
    s_waitcnt vmcnt(0)
    buffer_load_dwordx4 v[76:79], v105, s[36:39], s96 offen sc1
    buffer_load_dwordx4 v[80:83], v105, s[36:39], s97 offen sc1
    buffer_load_dwordx4 v[84:87], v105, s[36:39], s98 offen sc1
    buffer_load_dwordx4 v[88:91], v105, s[36:39], s24 offen sc1
    s_mov_b32 exec_lo, 0x11111111
    s_mov_b32 exec_hi, 0x11111111
    buffer_load_dword v194, v193, s[36:39], s26 offen offset:512 sc1
    s_mov_b64 exec, -1
LW_pi:
    s_mov_b32 s55, 200000
Lpay9:
    s_waitcnt vmcnt(5)
    s_nop 1
    v_max_f32_dpp v204, v72, v72 row_ror:1 row_mask:0xf bank_mask:0xf
    v_xor_b32 v2, s4, v73
    v_xor_b32 v3, s4, v75
    v_max_f32_dpp v204, v204, v204 row_ror:2 row_mask:0xf bank_mask:0xf
    v_or_b32 v2, v2, v3
    v_cmp_ne_u32 vcc, 0, v2
    v_max_f32_dpp v204, v204, v204 row_ror:4 row_mask:0xf bank_mask:0xf
    s_mov_b32 s27, vcc_lo
    s_nop 0
    v_max_f32_dpp v204, v204, v204 row_ror:8 row_mask:0xf bank_mask:0xf
    v_mov_b32 v206, v204
    s_nop 1
    v_permlane16_swap_b32 v204, v206
    v_max_f32 v204, v204, v206
    v_sub_f32 v204, v72, v204
    v_exp_f32 v204, v204
    s_nop 0
    ds_bpermute_b32 v196, v107, v204 offset:0
    ds_bpermute_b32 v198, v107, v204 offset:16
    ds_bpermute_b32 v200, v107, v204 offset:32
    ds_bpermute_b32 v202, v107, v204 offset:48
    v_mul_f32 v205, v204, v74
    s_nop 1
    v_add_f32_dpp v205, v205, v205 row_ror:1 row_mask:0xf bank_mask:0xf
    s_nop 1
    v_add_f32_dpp v205, v205, v205 row_ror:2 row_mask:0xf bank_mask:0xf
    s_nop 1
    v_add_f32_dpp v205, v205, v205 row_ror:4 row_mask:0xf bank_mask:0xf
    s_nop 1
    v_add_f32_dpp v205, v205, v205 row_ror:8 row_mask:0xf bank_mask:0xf
    s_nop 1
    v_mov_b32 v206, v205
    s_nop 1
    v_permlane16_swap_b32 v205, v206
    s_nop 1
    v_add_f32 v205, v205, v206
    s_nop 1
    v_rcp_f32 v205, v205
    s_nop 1
    v_readfirstlane_b32 s62, v205
    s_waitcnt lgkmcnt(0)
    s_waitcnt vmcnt(4)
    v_lshlrev_b32 v208, 16, v76
    v_and_b32 v209, 0xffff0000, v76
    v_lshlrev_b32 v210, 16, v77
    v_and_b32 v211, 0xffff0000, v77
    v_lshlrev_b32 v212, 16, v78
    v_and_b32 v213, 0xffff0000, v78
    v_lshlrev_b32 v214, 16, v79
    v_and_b32 v215, 0xffff0000, v79
    v_pk_mul_f32 v[92:93], v[208:209], v[196:197] op_sel_hi:[1,0]
    v_pk_mul_f32 v[94:95], v[210:211], v[196:197] op_sel_hi:[1,0]
    v_pk_mul_f32 v[96:97], v[212:213], v[196:197] op_sel_hi:[1,0]
    v_pk_mul_f32 v[98:99], v[214:215], v[196:197] op_sel_hi:[1,0]
    v_add3_u32 v142, v76, v77, v78
    v_add_u32 v142, v142, v79
    s_waitcnt vmcnt(3)
    v_lshlrev_b32 v208, 16, v80
    v_and_b32 v209, 0xffff0000, v80
    v_lshlrev_b32 v210, 16, v81
    v_and_b32 v211, 0xffff0000, v81
    v_lshlrev_b32 v212, 16, v82
    v_and_b32 v213, 0xffff0000, v82
    v_lshlrev_b32 v214, 16, v83
    v_and_b32 v215, 0xffff0000, v83
    v_pk_fma_f32 v[92:93], v[208:209], v[198:199], v[92:93] op_sel_hi:[1,0,1]
    v_pk_fma_f32 v[94:95], v[210:211], v[198:199], v[94:95] op_sel_hi:[1,0,1]
    v_pk_fma_f32 v[96:97], v[212:213], v[198:199], v[96:97] op_sel_hi:[1,0,1]
    v_pk_fma_f32 v[98:99], v[214:215], v[198:199], v[98:99] op_sel_hi:[1,0,1]
    v_add3_u32 v143, v80, v81, v82
    v_add_u32 v143, v143, v83
    s_waitcnt vmcnt(2)
    v_lshlrev_b32 v208, 16, v84
    v_and_b32 v209, 0xffff0000, v84
    v_lshlrev_b32 v210, 16, v85
    v_and_b32 v211, 0xffff0000, v85
    v_lshlrev_b32 v212, 16, v86
    v_and_b32 v213, 0xffff0000, v86
    v_lshlrev_b32 v214, 16, v87
    v_and_b32 v215, 0xffff0000, v87
    v_pk_fma_f32 v[92:93], v[208:209], v[200:201], v[92:93] op_sel_hi:[1,0,1]
    v_pk_fma_f32 v[94:95], v[210:211], v[200:201], v[94:95] op_sel_hi:[1,0,1]
    v_pk_fma_f32 v[96:97], v[212:213], v[200:201], v[96:97] op_sel_hi:[1,0,1]
    v_pk_fma_f32 v[98:99], v[214:215], v[200:201], v[98:99] op_sel_hi:[1,0,1]
    v_add3_u32 v144, v84, v85, v86
    v_add_u32 v144, v144, v87
    s_waitcnt vmcnt(1)
    v_lshlrev_b32 v208, 16, v88
    v_and_b32 v209, 0xffff0000, v88
    v_lshlrev_b32 v210, 16, v89
    v_and_b32 v211, 0xffff0000, v89
    v_lshlrev_b32 v212, 16, v90
    v_and_b32 v213, 0xffff0000, v90
    v_lshlrev_b32 v214, 16, v91
    v_and_b32 v215, 0xffff0000, v91
    v_pk_fma_f32 v[92:93], v[208:209], v[202:203], v[92:93] op_sel_hi:[1,0,1]
    v_pk_fma_f32 v[94:95], v[210:211], v[202:203], v[94:95] op_sel_hi:[1,0,1]
    v_pk_fma_f32 v[96:97], v[212:213], v[202:203], v[96:97] op_sel_hi:[1,0,1]
    v_pk_fma_f32 v[98:99], v[214:215], v[202:203], v[98:99] op_sel_hi:[1,0,1]
    v_add3_u32 v145, v88, v89, v90
    v_add_u32 v145, v145, v91
    v_permlane32_swap_b32 v92, v96
    v_permlane32_swap_b32 v93, v97
    v_permlane32_swap_b32 v94, v98
    v_permlane32_swap_b32 v95, v99
    v_add_u32_dpp v142, v142, v142 row_ror:8 row_mask:0xf bank_mask:0x3
    v_add_u32_dpp v143, v143, v143 row_ror:8 row_mask:0xf bank_mask:0x3
    v_pk_add_f32 v[92:93], v[92:93], v[96:97]
    v_pk_add_f32 v[94:95], v[94:95], v[98:99]
    v_add_u32_dpp v142, v144, v144 row_ror:8 row_mask:0xf bank_mask:0xc
    v_add_u32_dpp v143, v145, v145 row_ror:8 row_mask:0xf bank_mask:0xc
    v_pk_mul_f32 v[92:93], v[92:93], s[62:63] op_sel_hi:[1,0]
    v_pk_mul_f32 v[94:95], v[94:95], s[62:63] op_sel_hi:[1,0]
    v_cvt_pk_bf16_f32 v92, v92, v93
    v_cvt_pk_bf16_f32 v93, v94, v95
    ds_write_b64 v106, v[92:93]
    v_add_u32_dpp v142, v142, v142 row_half_mirror row_mask:0xf bank_mask:0x5
    v_add_u32_dpp v142, v143, v143 row_half_mirror row_mask:0xf bank_mask:0xa
    s_nop 1
    v_add_u32_dpp v142, v142, v142 quad_perm:[1,0,3,2] row_mask:0xf bank_mask:0xf
    s_nop 1
    v_add_u32_dpp v142, v142, v142 quad_perm:[2,3,0,1] row_mask:0xf bank_mask:0xf
    s_waitcnt vmcnt(0)
    v_xor_b32 v142, s4, v142
    v_cmp_ne_u32 vcc, v142, v194
    s_waitcnt lgkmcnt(0)
    s_or_b32 s62, vcc_lo, vcc_hi
    s_and_b32 s62, s62, 0x11111111
    s_or_b32 s62, s62, s27
    s_cbranch_scc0 Lpayd10
    s_mov_b32 exec_hi, 0
    buffer_load_dwordx4 v[72:75], v104, s[36:39], s0 offen sc1
    s_mov_b64 exec, -1
    buffer_load_dwordx4 v[76:79], v105, s[36:39], s96 offen sc1
    buffer_load_dwordx4 v[80:83], v105, s[36:39], s97 offen sc1
    buffer_load_dwordx4 v[84:87], v105, s[36:39], s98 offen sc1
    buffer_load_dwordx4 v[88:91], v105, s[36:39], s24 offen sc1
    s_mov_b32 exec_lo, 0x11111111
    s_mov_b32 exec_hi, 0x11111111
    buffer_load_dword v194, v193, s[36:39], s26 offen offset:512 sc1
    s_mov_b64 exec, -1
    s_waitcnt vmcnt(0)
    s_sub_u32 s55, s55, 1
    s_cbranch_scc0 Lpay9
Lpayd10:
    s_cmp_eq_u32 s18, 0
    s_cbranch_scc1 LW_fd2
    s_mov_b32 s55, 199999
Lpoll11:
    s_mov_b32 s62, s25
    s_add_u32 s99, s16, s62
    buffer_load_dwordx4 v[124:127], v240, s[36:39], s99 offen offset:0 sc1
    s_add_u32 s100, s17, s62
    buffer_load_dwordx4 v[128:131], v240, s[36:39], s100 offen offset:0 sc1
    s_waitcnt vmcnt(0)
    v_xor_b32 v2, s4, v125
    v_xor_b32 v3, s4, v127
    v_xor_b32 v4, s4, v129
    v_xor_b32 v5, s4, v131
    v_or3_b32 v2, v2, v4, v5
    v_or_b32 v2, v2, v3
    v_cmp_ne_u32 vcc, 0, v2
    s_cbranch_vccz Ldone12
    s_sleep 1
    s_sub_u32 s55, s55, 1
    s_cbranch_scc0 Lpoll11
Ldone12:
    s_branch LW_fok
LW_fdone:
    s_waitcnt lgkmcnt(0)
LW_fd2:
    s_barrier
    ds_read2st64_b64 v[20:23], v17 offset0:8 offset1:9
    ds_read2st64_b64 v[24:27], v17 offset0:10 offset1:11
    ds_read2st64_b64 v[28:31], v17 offset0:12 offset1:13
    ds_read2st64_b64 v[32:35], v17 offset0:14 offset1:15
    ds_read2st64_b64 v[224:227], v17 offset0:26 offset1:27
    ds_read2st64_b64 v[228:231], v17 offset0:28 offset1:29
    s_waitcnt lgkmcnt(2)
    v_mfma_f32_16x16x32_bf16 v[244:247], v[36:39], v[20:23], 0
    v_mfma_f32_16x16x32_bf16 v[244:247], v[40:43], v[24:27], v[244:247]
    v_mfma_f32_16x16x32_bf16 v[244:247], v[44:47], v[28:31], v[244:247]
    v_mfma_f32_16x16x32_bf16 v[244:247], v[48:51], v[32:35], v[244:247]
    s_waitcnt lgkmcnt(0)
    v_mfma_f32_16x16x32_bf16 v[148:151], v[116:119], v[224:227], 0
    v_mfma_f32_16x16x32_bf16 v[148:151], v[120:123], v[228:231], v[148:151]
    s_nop 4
    v_add_f32_dpp v244, v244, v244 row_ror:8 row_mask:0xf bank_mask:0xf
    v_add_f32_dpp v245, v245, v245 row_ror:8 row_mask:0xf bank_mask:0xf
    v_add_f32_dpp v246, v246, v246 row_ror:8 row_mask:0xf bank_mask:0xf
    v_add_f32_dpp v247, v247, v247 row_ror:8 row_mask:0xf bank_mask:0xf
    v_add_f32_dpp v244, v244, v244 row_ror:4 row_mask:0xf bank_mask:0xf
    v_add_f32_dpp v245, v245, v245 row_ror:4 row_mask:0xf bank_mask:0xf
    v_add_f32_dpp v246, v246, v246 row_ror:4 row_mask:0xf bank_mask:0xf
    v_add_f32_dpp v247, v247, v247 row_ror:4 row_mask:0xf bank_mask:0xf
    v_cvt_pk_bf16_f32 v248, v244, v245
    v_cvt_pk_bf16_f32 v250, v246, v247
    s_mov_b64 exec, s[48:49]
    buffer_store_dwordx4 v[248:251], v240, s[36:39], s60 offen
    s_mov_b64 exec, -1
    buffer_load_dwordx4 v12, s[44:47], s30 offen offset:0 nt lds
    buffer_load_dwordx4 v13, s[44:47], s31 offen offset:1024 nt lds
    buffer_load_dwordx4 v12, s[44:47], s32 offen offset:2048 nt lds
    buffer_load_dwordx4 v13, s[44:47], s33 offen offset:3072 nt lds
    s_cmp_eq_u32 s25, 0
    s_cbranch_scc1 Lng13
    s_add_u32 s62, s60, 6815744
    s_mov_b64 exec, s[48:49]
    buffer_store_dwordx4 v[248:251], v240, s[36:39], s62 offen sc1
    s_mov_b64 exec, -1
Lng13:
    v_sub_f32 v6, 1.0, v159
    v_add_u32 v7, 8192, v18
    s_mov_b32 vcc_lo, 0xf0f0f0f0
    s_mov_b32 vcc_hi, 0xf0f0f0f0
    v_cndmask_b32 v152, v148, v150, vcc
    v_cndmask_b32 v154, v149, v151, vcc
    v_mul_f32 v152, v6, v152
    v_mul_f32 v154, v6, v154
    s_cmp_lt_u32 s5, 28
    s_cbranch_scc1 LW_fz
    v_mov_b32 v152, 0
    v_mov_b32 v154, 0
LW_fz:
    v_mov_b32 v153, s4
    v_mov_b32 v155, s4
    s_mov_b32 s55, 199999
Lpoll14:
    s_mov_b32 s62, s25
    s_add_u32 s99, s60, s62
    buffer_load_dwordx4 v[72:75], v240, s[36:39], s99 offen offset:0 sc1
    s_waitcnt vmcnt(0)
    v_xor_b32 v2, s4, v73
    v_xor_b32 v3, s4, v75
    v_or_b32 v2, v2, v3
    v_cmp_ne_u32 vcc, 0, v2
    s_cbranch_vccz Ldone15
    s_sleep 1
    s_sub_u32 s55, s55, 1
    s_cbranch_scc0 Lpoll14
Ldone15:
    ds_write2_b32 v7, v72, v74 offset0:0 offset1:1
    s_waitcnt lgkmcnt(0)
    s_barrier
    s_cmp_lg_u32 s3, 0
    s_cbranch_scc1 Lnh16
    s_mov_b32 exec_hi, 0
    s_mov_b32 exec_lo, 0xff
    buffer_store_byte v249, v156, s[36:39], s7 offen sc1
    s_mov_b64 exec, -1
Lnh16:
    ds_read2st64_b64 v[20:23], v17 offset0:16 offset1:17
    ds_read2st64_b64 v[24:27], v17 offset0:18 offset1:19
    ds_read2st64_b64 v[28:31], v17 offset0:20 offset1:21
    ds_read2st64_b64 v[32:35], v17 offset0:22 offset1:23
    ds_read_b64_tr_b16 v[52:53], v14 offset:0
    ds_read_b64_tr_b16 v[54:55], v14 offset:4096
    ds_read_b64_tr_b16 v[56:57], v14 offset:8192
    ds_read_b64_tr_b16 v[58:59], v14 offset:12288
    ds_read_b64_tr_b16 v[60:61], v14 offset:16384
    ds_read_b64_tr_b16 v[62:63], v14 offset:20480
    ds_read_b64_tr_b16 v[64:65], v14 offset:24576
    ds_read_b64_tr_b16 v[66:67], v14 offset:28672
    s_mov_b32 vcc_lo, 0xf0f0f0f0
    s_mov_b32 vcc_hi, 0xf0f0f0f0
    s_waitcnt lgkmcnt(0)
    v_mfma_f32_16x16x32_bf16 v[244:247], v[52:55], v[20:23], 0
    v_mfma_f32_16x16x32_bf16 v[244:247], v[56:59], v[24:27], v[244:247]
    v_mfma_f32_16x16x32_bf16 v[244:247], v[60:63], v[28:31], v[244:247]
    v_mfma_f32_16x16x32_bf16 v[244:247], v[64:67], v[32:35], v[244:247]
    s_nop 7
    v_add_f32_dpp v244, v244, v244 row_ror:8 row_mask:0xf bank_mask:0xf
    v_add_f32_dpp v245, v245, v245 row_ror:8 row_mask:0xf bank_mask:0xf
    v_add_f32_dpp v246, v246, v246 row_ror:8 row_mask:0xf bank_mask:0xf
    v_add_f32_dpp v247, v247, v247 row_ror:8 row_mask:0xf bank_mask:0xf
    v_add_f32_dpp v244, v244, v244 row_ror:4 row_mask:0xf bank_mask:0xf
    v_add_f32_dpp v245, v245, v245 row_ror:4 row_mask:0xf bank_mask:0xf
    v_add_f32_dpp v246, v246, v246 row_ror:4 row_mask:0xf bank_mask:0xf
    v_add_f32_dpp v247, v247, v247 row_ror:4 row_mask:0xf bank_mask:0xf
    v_cndmask_b32 v2, v244, v246, vcc
    v_cndmask_b32 v3, v245, v247, vcc
    s_mov_b32 exec_lo, 0x00ff00ff
    s_mov_b32 exec_hi, 0x00ff00ff
    v_fmac_f32 v152, v159, v2
    v_fmac_f32 v154, v159, v3
    buffer_store_dwordx4 v[152:155], v19, s[36:39], s61 offen sc1
    s_mov_b64 exec, -1
    s_or_b32 s62, s2, s3
    s_cbranch_scc1 LW_noep
    s_mov_b64 exec, 1
    v_mov_b32 v3, 0
    buffer_store_dword v249, v3, s[36:39], 0 offen offset:0 sc1
    s_mov_b64 exec, -1
LW_noep:
    s_endpgm
.p2align 12
LA_role:
    s_sub_u32 s57, s2, 128
    s_bfe_u32 s58, s2, 0x20001
    s_bfe_u32 s96, s57, 0x20001
    s_lshl_b32 s96, s96, 5
    s_bfe_u32 s63, s57, 0x40003
    s_lshl_b32 s63, s63, 1
    s_add_u32 s96, s96, s63
    s_and_b32 s63, s57, 1
    s_add_u32 s96, s96, s63
    s_cmp_ge_u32 s3, 4
    s_cbranch_scc1 LA_helper
    s_mov_b32 m0, s51
    s_lshl_b32 s62, s6, 20
    s_lshl_b32 s63, s3, 18
    s_add_u32 s62, s62, s63
    s_lshl_b32 s63, s5, 8
    s_add_u32 s62, s62, s63
    v_lshrrev_b32 v2, 1, v1
    v_and_b32 v3, 1, v1
    v_lshlrev_b32 v3, 7, v3
    v_lshl_add_u32 v2, v2, 13, v3
    v_add_u32 v26, s62, v2
    v_lshrrev_b32 v4, 3, v1
    v_and_b32 v3, 7, v1
    v_lshrrev_b32 v2, 2, v1
    v_and_b32 v2, 4, v2
    v_lshrrev_b32 v5, 5, v1
    v_or_b32 v2, v2, v5
    v_xor_b32 v3, v3, v2
    v_lshlrev_b32 v3, 4, v3
    v_lshl_add_u32 v8, v4, 10, v3
    v_xor_b32 v9, 32, v8
    s_lshl_b32 s50, s96, 17
    s_lshl_b32 s62, s3, 15
    s_add_u32 s50, s50, s62
    s_add_u32 s52, s50, 7168
    s_add_u32 s53, s50, 14336
    s_add_u32 s54, s50, 21504
    s_mov_b32 s46, 0x1000000
    s_waitcnt lgkmcnt(0)
    s_load_dword s4, s[34:35], 0
    s_mov_b32 s44, s10
    s_mov_b32 s45, s11
    s_mov_b32 s36, s34
    s_mov_b32 s37, s35
    s_waitcnt lgkmcnt(0)
    global_load_dword v21, v26, s[14:15]
    s_add_u32 m0, s51, 0
    s_nop 0
    buffer_load_dwordx4 v8, s[44:47], s50 offen offset:0 nt lds
    s_add_u32 m0, s51, 16256
    s_nop 0
    buffer_load_dwordx4 v8, s[44:47], s50 offen offset:128 nt lds
    s_add_u32 m0, s51, 32512
    s_nop 0
    buffer_load_dwordx4 v8, s[44:47], s50 offen offset:256 nt lds
    s_add_u32 m0, s51, 48768
    s_nop 0
    buffer_load_dwordx4 v8, s[44:47], s50 offen offset:384 nt lds
    v_and_b32 v2, 31, v1
    v_lshlrev_b32 v3, 1, v1
    v_and_b32 v3, 4, v3
    v_bfe_u32 v4, v1, 2, 2
    v_or_b32 v3, v3, v4
    v_xor_b32 v3, v3, v5
    v_lshlrev_b32 v3, 4, v3
    v_lshl_add_u32 v3, v2, 7, v3
    v_add_u32 v10, s51, v3
    v_xor_b32 v11, 32, v10
    v_xor_b32 v12, 64, v10
    v_xor_b32 v13, 96, v10
    v_xor_b32 v3, v2, v5
    v_lshlrev_b32 v3, 4, v3
    v_lshl_add_u32 v3, v5, 9, v3
    v_add_u32 v14, 131072, v3
    v_xor_b32 v15, 1056, v14
    v_xor_b32 v16, 2112, v14
    v_xor_b32 v17, 3168, v14
    v_lshlrev_b32 v29, 4, v2
    v_add_u32 v29, 131072, v29
    s_lshl_b32 s62, s3, 2
    v_add_u32 v28, s62, v29
    v_mul_u32_u24 v31, 272, v2
    v_lshl_add_u32 v31, v5, 3, v31
    s_lshl_b32 s62, s3, 6
    s_add_u32 s62, s62, 133120
    v_add_u32 v31, s62, v31
    v_lshlrev_b32 v18, 12, v1
    s_lshl_b32 s60, s58, 10
    s_add_u32 s60, s60, 8126464
    s_and_b32 s61, s57, 1
    s_lshl_b32 s61, s61, 4
    s_lshr_b32 s62, s57, 3
    s_add_u32 s61, s61, s62
    s_lshl_b32 s62, s5, 17
    s_lshl_b32 s63, s3, 15
    s_add_u32 s62, s62, s63
    s_lshl_b32 s63, s6, 8
    s_add_u32 s62, s62, s63
    v_lshrrev_b32 v2, 1, v1
    v_and_b32 v3, 1, v1
    v_lshlrev_b32 v3, 7, v3
    v_lshl_add_u32 v2, v2, 10, v3
    v_add_u32 v20, s62, v2
    v_bfe_u32 v2, v1, 2, 3
    v_and_b32 v3, 3, v1
    v_lshl_add_u32 v2, v3, 3, v2
    v_lshlrev_b32 v25, 2, v2
    v_lshlrev_b32 v2, 4, v2
    v_add_u32 v23, 131072, v2
    v_lshlrev_b32 v24, 4, v1
    s_lshl_b32 s59, s96, 11
    s_add_u32 s59, s59, 6291456
    s_lshr_b32 s100, s61, 3
    s_lshl_b32 s100, s100, 7
    s_add_u32 s60, s60, s100
    s_and_b32 s100, s61, 7
    s_add_u32 s60, s60, s100
    s_waitcnt lgkmcnt(0)
    s_mul_i32 s4, s4, 1664525
    s_add_u32 s4, s4, 1013904223
    v_mov_b32 v19, s4
    s_waitcnt vmcnt(4)
    s_add_u32 m0, s51, 65024
    s_nop 0
    buffer_load_dwordx4 v8, s[44:47], s50 offen offset:512 nt lds
    s_add_u32 m0, s51, 0
    s_nop 0
    buffer_load_dwordx4 v9, s[44:47], s52 offen offset:1024 nt lds
    s_add_u32 m0, s51, 16256
    s_nop 0
    buffer_load_dwordx4 v9, s[44:47], s52 offen offset:1152 nt lds
    s_add_u32 m0, s51, 32512
    s_nop 0
    buffer_load_dwordx4 v9, s[44:47], s52 offen offset:1280 nt lds
    s_add_u32 m0, s51, 48768
    s_nop 0
    buffer_load_dwordx4 v9, s[44:47], s52 offen offset:1408 nt lds
    s_add_u32 m0, s51, 65024
    s_nop 0
    buffer_load_dwordx4 v9, s[44:47], s52 offen offset:1536 nt lds
    s_add_u32 m0, s51, 0
    s_nop 0
    buffer_load_dwordx4 v8, s[44:47], s53 offen offset:2048 nt lds
    s_add_u32 m0, s51, 16256
    s_nop 0
    buffer_load_dwordx4 v8, s[44:47], s53 offen offset:2176 nt lds
    s_add_u32 m0, s51, 32512
    s_nop 0
    buffer_load_dwordx4 v8, s[44:47], s53 offen offset:2304 nt lds
    s_add_u32 m0, s51, 48768
    s_nop 0
    buffer_load_dwordx4 v8, s[44:47], s53 offen offset:2432 nt lds
    s_add_u32 m0, s51, 65024
    s_nop 0
    buffer_load_dwordx4 v8, s[44:47], s53 offen offset:2560 nt lds
    s_add_u32 m0, s51, 0
    s_nop 0
    buffer_load_dwordx4 v9, s[44:47], s54 offen offset:3072 nt lds
    s_add_u32 m0, s51, 16256
    s_nop 0
    buffer_load_dwordx4 v9, s[44:47], s54 offen offset:3200 nt lds
    s_add_u32 m0, s51, 32512
    s_nop 0
    buffer_load_dwordx4 v9, s[44:47], s54 offen offset:3328 nt lds
    s_add_u32 m0, s51, 48768
    s_nop 0
    buffer_load_dwordx4 v9, s[44:47], s54 offen offset:3456 nt lds
    s_add_u32 m0, s51, 65024
    s_nop 0
    buffer_load_dwordx4 v9, s[44:47], s54 offen offset:3584 nt lds
    s_mov_b32 m0, s51
    s_barrier
    v_add_u32 v8, 640, v8
    v_add_u32 v9, 640, v9
    s_add_u32 m0, m0, 81920
    s_mov_b32 s55, 3
Lckv17:
    buffer_load_dwordx4 v8, s[44:47], s50 offen offset:0 nt lds
    buffer_load_dwordx4 v9, s[44:47], s52 offen offset:1024 nt lds
    buffer_load_dwordx4 v8, s[44:47], s53 offen offset:2048 nt lds
    buffer_load_dwordx4 v9, s[44:47], s54 offen offset:3072 nt lds
    v_add_u32 v8, 0x80, v8
    v_add_u32 v9, 0x80, v9
    s_add_u32 m0, m0, 16384
    s_sub_u32 s55, s55, 1
    s_cmp_lg_u32 s55, 0
    s_cbranch_scc1 Lckv17
    global_load_dword v21, v26, s[16:17]
    s_waitcnt vmcnt(13)
    ds_read_b128 v[48:51], v10 offset:0
    ds_read_b128 v[52:55], v11 offset:0
    ds_read_b128 v[56:59], v12 offset:0
    ds_read_b128 v[60:63], v13 offset:0
    s_setprio 3
    s_barrier
    ds_read_b128 v[80:83], v14 offset:0
    ds_read_b128 v[84:87], v15 offset:0
    ds_read_b128 v[88:91], v16 offset:0
    ds_read_b128 v[92:95], v17 offset:0
    s_waitcnt vmcnt(13)
    s_waitcnt lgkmcnt(3)
    v_mfma_f32_32x32x16_bf16 v[32:47], v[48:51], v[80:83], 0
    ds_read_b128 v[64:67], v10 offset:16384
    ds_read_b128 v[96:99], v14 offset:4096
    s_waitcnt lgkmcnt(4)
    s_barrier
    v_mfma_f32_32x32x16_bf16 v[32:47], v[52:55], v[84:87], v[32:47]
    ds_read_b128 v[68:71], v11 offset:16384
    ds_read_b128 v[100:103], v15 offset:4096
    s_waitcnt lgkmcnt(5)
    v_mfma_f32_32x32x16_bf16 v[32:47], v[56:59], v[88:91], v[32:47]
    ds_read_b128 v[72:75], v12 offset:16384
    ds_read_b128 v[104:107], v16 offset:4096
    s_waitcnt lgkmcnt(6)
    v_mfma_f32_32x32x16_bf16 v[32:47], v[60:63], v[92:95], v[32:47]
    ds_read_b128 v[76:79], v13 offset:16384
    ds_read_b128 v[108:111], v17 offset:4096
    s_waitcnt vmcnt(13)
    s_waitcnt lgkmcnt(6)
    v_mfma_f32_32x32x16_bf16 v[32:47], v[64:67], v[96:99], v[32:47]
    ds_read_b128 v[48:51], v10 offset:32768
    ds_read_b128 v[80:83], v14 offset:8192
    s_waitcnt lgkmcnt(6)
    v_mfma_f32_32x32x16_bf16 v[32:47], v[68:71], v[100:103], v[32:47]
    ds_read_b128 v[52:55], v11 offset:32768
    ds_read_b128 v[84:87], v15 offset:8192
    s_waitcnt lgkmcnt(6)
    v_mfma_f32_32x32x16_bf16 v[32:47], v[72:75], v[104:107], v[32:47]
    ds_read_b128 v[56:59], v12 offset:32768
    ds_read_b128 v[88:91], v16 offset:8192
    s_waitcnt lgkmcnt(6)
    v_mfma_f32_32x32x16_bf16 v[32:47], v[76:79], v[108:111], v[32:47]
    ds_read_b128 v[60:63], v13 offset:32768
    ds_read_b128 v[92:95], v17 offset:8192
    s_waitcnt vmcnt(13)
    s_waitcnt lgkmcnt(6)
    v_mfma_f32_32x32x16_bf16 v[32:47], v[48:51], v[80:83], v[32:47]
    ds_read_b128 v[64:67], v10 offset:49152
    ds_read_b128 v[96:99], v14 offset:12288
    s_waitcnt lgkmcnt(6)
    v_mfma_f32_32x32x16_bf16 v[32:47], v[52:55], v[84:87], v[32:47]
    ds_read_b128 v[68:71], v11 offset:49152
    ds_read_b128 v[100:103], v15 offset:12288
    s_waitcnt lgkmcnt(6)
    v_mfma_f32_32x32x16_bf16 v[32:47], v[56:59], v[88:91], v[32:47]
    ds_read_b128 v[72:75], v12 offset:49152
    ds_read_b128 v[104:107], v16 offset:12288
    s_waitcnt lgkmcnt(6)
    v_mfma_f32_32x32x16_bf16 v[32:47], v[60:63], v[92:95], v[32:47]
    ds_read_b128 v[76:79], v13 offset:49152
    ds_read_b128 v[108:111], v17 offset:12288
    s_waitcnt vmcnt(13)
    s_waitcnt lgkmcnt(6)
    v_mfma_f32_32x32x16_bf16 v[32:47], v[64:67], v[96:99], v[32:47]
    v_xor_b32 v10, 0x10000, v10
    ds_read_b128 v[48:51], v10 offset:0
    ds_read_b128 v[80:83], v14 offset:16384
    s_waitcnt lgkmcnt(6)
    v_mfma_f32_32x32x16_bf16 v[32:47], v[68:71], v[100:103], v[32:47]
    v_xor_b32 v11, 0x10000, v11
    ds_read_b128 v[52:55], v11 offset:0
    ds_read_b128 v[84:87], v15 offset:16384
    s_waitcnt lgkmcnt(6)
    v_mfma_f32_32x32x16_bf16 v[32:47], v[72:75], v[104:107], v[32:47]
    v_xor_b32 v12, 0x10000, v12
    ds_read_b128 v[56:59], v12 offset:0
    ds_read_b128 v[88:91], v16 offset:16384
    s_waitcnt lgkmcnt(6)
    v_mfma_f32_32x32x16_bf16 v[32:47], v[76:79], v[108:111], v[32:47]
    v_xor_b32 v13, 0x10000, v13
    ds_read_b128 v[60:63], v13 offset:0
    ds_read_b128 v[92:95], v17 offset:16384
    s_waitcnt vmcnt(9)
    s_waitcnt lgkmcnt(6)
    v_mfma_f32_32x32x16_bf16 v[32:47], v[48:51], v[80:83], v[32:47]
    ds_read_b128 v[64:67], v10 offset:16384
    ds_read_b128 v[96:99], v14 offset:20480
    s_waitcnt lgkmcnt(6)
    v_mfma_f32_32x32x16_bf16 v[32:47], v[52:55], v[84:87], v[32:47]
    ds_read_b128 v[68:71], v11 offset:16384
    ds_read_b128 v[100:103], v15 offset:20480
    s_waitcnt lgkmcnt(6)
    v_mfma_f32_32x32x16_bf16 v[32:47], v[56:59], v[88:91], v[32:47]
    ds_read_b128 v[72:75], v12 offset:16384
    ds_read_b128 v[104:107], v16 offset:20480
    s_waitcnt lgkmcnt(6)
    v_mfma_f32_32x32x16_bf16 v[32:47], v[60:63], v[92:95], v[32:47]
    ds_read_b128 v[76:79], v13 offset:16384
    ds_read_b128 v[108:111], v17 offset:20480
    s_waitcnt vmcnt(5)
    s_waitcnt lgkmcnt(6)
    v_mfma_f32_32x32x16_bf16 v[32:47], v[64:67], v[96:99], v[32:47]
    ds_read_b128 v[48:51], v10 offset:32768
    ds_read_b128 v[80:83], v14 offset:24576
    s_waitcnt lgkmcnt(6)
    v_mfma_f32_32x32x16_bf16 v[32:47], v[68:71], v[100:103], v[32:47]
    ds_read_b128 v[52:55], v11 offset:32768
    ds_read_b128 v[84:87], v15 offset:24576
    s_waitcnt lgkmcnt(6)
    v_mfma_f32_32x32x16_bf16 v[32:47], v[72:75], v[104:107], v[32:47]
    ds_read_b128 v[56:59], v12 offset:32768
    ds_read_b128 v[88:91], v16 offset:24576
    s_waitcnt lgkmcnt(6)
    v_mfma_f32_32x32x16_bf16 v[32:47], v[76:79], v[108:111], v[32:47]
    ds_read_b128 v[60:63], v13 offset:32768
    ds_read_b128 v[92:95], v17 offset:24576
    s_waitcnt vmcnt(1)
    s_waitcnt lgkmcnt(6)
    v_mfma_f32_32x32x16_bf16 v[32:47], v[48:51], v[80:83], v[32:47]
    ds_read_b128 v[64:67], v10 offset:49152
    ds_read_b128 v[96:99], v14 offset:28672
    s_waitcnt lgkmcnt(6)
    v_mfma_f32_32x32x16_bf16 v[32:47], v[52:55], v[84:87], v[32:47]
    ds_read_b128 v[68:71], v11 offset:49152
    ds_read_b128 v[100:103], v15 offset:28672
    s_waitcnt lgkmcnt(6)
    v_mfma_f32_32x32x16_bf16 v[32:47], v[56:59], v[88:91], v[32:47]
    ds_read_b128 v[72:75], v12 offset:49152
    ds_read_b128 v[104:107], v16 offset:28672
    s_waitcnt lgkmcnt(6)
    v_mfma_f32_32x32x16_bf16 v[32:47], v[60:63], v[92:95], v[32:47]
    ds_read_b128 v[76:79], v13 offset:49152
    ds_read_b128 v[108:111], v17 offset:28672
    s_barrier
    s_waitcnt lgkmcnt(6)
    v_mfma_f32_32x32x16_bf16 v[32:47], v[64:67], v[96:99], v[32:47]
    s_waitcnt lgkmcnt(4)
    v_mfma_f32_32x32x16_bf16 v[32:47], v[68:71], v[100:103], v[32:47]
    s_waitcnt lgkmcnt(2)
    v_mfma_f32_32x32x16_bf16 v[32:47], v[72:75], v[104:107], v[32:47]
    s_waitcnt lgkmcnt(0)
    v_mfma_f32_32x32x16_bf16 v[32:47], v[76:79], v[108:111], v[32:47]
    s_nop 12
    v_max3_f32 v2, v32, v33, v34
    v_max3_f32 v3, v35, v36, v37
    v_max3_f32 v2, v2, v38, v39
    v_max3_f32 v3, v3, v40, v41
    v_max3_f32 v2, v2, v42, v43
    v_max3_f32 v3, v3, v44, v45
    v_max3_f32 v2, v2, v46, v47
    v_max_f32 v2, v2, v3
    v_max_f32 v3, v2, v3
    s_nop 1
    v_permlane32_swap_b32 v2, v3
    v_max_f32 v2, v2, v3
    ds_write_b32 v28, v2
    s_waitcnt lgkmcnt(0)
    s_barrier
    ds_read_b128 v[48:51], v29
    s_waitcnt lgkmcnt(0)
    v_max3_f32 v2, v48, v49, v50
    v_max_f32 v2, v2, v51
    v_sub_f32 v32, v32, v2
    v_sub_f32 v33, v33, v2
    v_sub_f32 v34, v34, v2
    v_sub_f32 v35, v35, v2
    v_exp_f32 v32, v32
    v_exp_f32 v33, v33
    v_exp_f32 v34, v34
    v_exp_f32 v35, v35
    v_sub_f32 v36, v36, v2
    v_sub_f32 v37, v37, v2
    v_sub_f32 v38, v38, v2
    v_sub_f32 v39, v39, v2
    v_exp_f32 v36, v36
    v_exp_f32 v37, v37
    v_exp_f32 v38, v38
    v_exp_f32 v39, v39
    v_cvt_pk_bf16_f32 v48, v32, v33
    v_cvt_pk_bf16_f32 v49, v34, v35
    ds_write_b64 v31, v[48:49] offset:0
    v_sub_f32 v40, v40, v2
    v_sub_f32 v41, v41, v2
    v_sub_f32 v42, v42, v2
    v_sub_f32 v43, v43, v2
    v_exp_f32 v40, v40
    v_exp_f32 v41, v41
    v_exp_f32 v42, v42
    v_exp_f32 v43, v43
    v_cvt_pk_bf16_f32 v50, v36, v37
    v_cvt_pk_bf16_f32 v51, v38, v39
    ds_write_b64 v31, v[50:51] offset:16
    v_sub_f32 v44, v44, v2
    v_sub_f32 v45, v45, v2
    v_sub_f32 v46, v46, v2
    v_sub_f32 v47, v47, v2
    v_exp_f32 v44, v44
    v_exp_f32 v45, v45
    v_exp_f32 v46, v46
    v_exp_f32 v47, v47
    v_cvt_pk_bf16_f32 v52, v40, v41
    v_cvt_pk_bf16_f32 v53, v42, v43
    ds_write_b64 v31, v[52:53] offset:32
    v_cvt_pk_bf16_f32 v54, v44, v45
    v_cvt_pk_bf16_f32 v55, v46, v47
    ds_write_b64 v31, v[54:55] offset:48
    v_pk_add_f32 v[32:33], v[32:33], v[40:41]
    v_pk_add_f32 v[34:35], v[34:35], v[42:43]
    v_pk_add_f32 v[36:37], v[36:37], v[44:45]
    v_pk_add_f32 v[38:39], v[38:39], v[46:47]
    v_pk_add_f32 v[32:33], v[32:33], v[36:37]
    v_pk_add_f32 v[34:35], v[34:35], v[38:39]
    v_pk_add_f32 v[32:33], v[32:33], v[34:35]
    v_add_f32 v34, v32, v33
    v_add_f32 v35, v32, v33
    v_mov_b32 v5, s4
    v_mov_b32 v7, s4
    v_permlane32_swap_b32 v34, v35
    v_add_f32 v32, v34, v35
    ds_write_b32 v28, v32 offset:512
    ds_bpermute_b32 v4, v25, v2
    s_waitcnt lgkmcnt(0)
    s_barrier
    s_cmp_lg_u32 s3, 0
    s_cbranch_scc1 LA_noml
    ds_read_b128 v[40:43], v23 offset:512
    s_waitcnt lgkmcnt(0)
    v_pk_add_f32 v[40:41], v[40:41], v[42:43]
    v_add_f32 v6, v40, v41
    s_mov_b32 exec_hi, 0
    buffer_store_dwordx4 v[4:7], v24, s[36:39], s59 offen sc1
    s_mov_b64 exec, -1
LA_noml:
    s_barrier
    global_load_dword v21, v20, s[18:19]
    s_branch LA_end
.p2align 12
LA_helper:
    s_sub_u32 s97, s3, 4
    s_setprio 2
    s_waitcnt lgkmcnt(0)
    s_load_dword s4, s[34:35], 0
    s_mov_b32 s36, s34
    s_mov_b32 s37, s35
    s_waitcnt lgkmcnt(0)
    s_mul_i32 s4, s4, 1664525
    s_add_u32 s4, s4, 1013904223
    v_lshrrev_b32 v2, 4, v1
    v_bfe_u32 v3, v1, 2, 2
    v_lshl_add_u32 v4, v2, 3, v3
    v_lshlrev_b32 v4, 7, v4
    v_lshrrev_b32 v5, 1, v3
    v_lshlrev_b32 v5, 2, v5
    v_and_b32 v6, 1, v2
    v_lshl_or_b32 v5, v6, 1, v5
    v_bfe_u32 v7, v1, 1, 1
    v_xor_b32 v5, v5, v7
    v_lshl_add_u32 v4, v5, 4, v4
    v_and_b32 v5, 1, v1
    v_lshl_add_u32 v4, v5, 3, v4
    s_lshl_b32 s62, s97, 15
    v_add_u32 v18, s62, v4
    v_xor_b32 v19, 528, v18
    v_xor_b32 v20, 32, v18
    v_xor_b32 v21, 560, v18
    v_xor_b32 v22, 64, v18
    v_xor_b32 v23, 592, v18
    v_xor_b32 v24, 96, v18
    v_xor_b32 v25, 624, v18
    v_and_b32 v4, 15, v1
    v_mul_u32_u24 v26, 272, v4
    v_lshl_add_u32 v26, v2, 4, v26
    v_add_u32 v26, 133120, v26
    v_lshlrev_b32 v27, 4, v1
    v_lshl_or_b32 v3, v3, 1, v5
    v_lshl_add_u32 v6, v2, 3, v3
    v_lshlrev_b32 v28, 2, v6
    v_lshlrev_b32 v29, 12, v1
    v_lshlrev_b32 v4, 4, v4
    v_lshl_add_u32 v8, v2, 11, v4
    v_lshlrev_b32 v3, 13, v3
    v_lshl_add_u32 v10, v2, 11, v3
    v_and_b32 v2, 7, v1
    v_lshlrev_b32 v2, 4, v2
    v_lshl_add_u32 v2, v1, 9, v2
    s_lshl_b32 s62, s97, 7
    s_add_u32 s62, s62, 131072
    v_add_u32 v9, s62, v2
    s_lshl_b32 s59, s96, 15
    s_lshl_b32 s62, s97, 13
    s_add_u32 s59, s59, s62
    s_add_u32 s59, s59, 2097152
    s_add_u32 s56, s59, 4096
    s_lshl_b32 s61, s96, 11
    s_lshl_b32 s62, s97, 7
    s_add_u32 s61, s61, s62
    s_add_u32 s61, s61, 6291456
    s_lshl_b32 s50, s97, 16
    s_add_u32 s50, s50, 6815744
    s_lshl_b32 s62, s58, 6
    s_add_u32 s51, s50, s62
    s_lshl_b32 s62, s58, 8
    s_add_u32 s50, s50, s62
    s_lshr_b32 s52, s57, 2
    s_lshl_b32 s52, s52, 12
    s_lshl_b32 s62, s97, 10
    s_add_u32 s52, s52, s62
    s_add_u32 s52, s52, 7864320
    v_lshrrev_b32 v2, 1, v1
    v_lshlrev_b32 v3, 7, v5
    s_lshl_b32 s62, s6, 20
    s_lshl_b32 s63, s97, 18
    s_add_u32 s62, s62, s63
    s_lshl_b32 s63, s5, 8
    s_add_u32 s62, s62, s63
    v_lshl_add_u32 v12, v2, 13, v3
    v_add_u32 v12, s62, v12
    s_lshl_b32 s62, s5, 17
    s_lshl_b32 s63, s97, 15
    s_add_u32 s62, s62, s63
    s_lshl_b32 s63, s6, 8
    s_add_u32 s62, s62, s63
    v_lshl_add_u32 v13, v2, 10, v3
    v_add_u32 v13, s62, v13
    v_mov_b32 v31, s4
    s_lshl_b32 s60, s58, 10
    s_add_u32 s60, s60, 8126464
    s_and_b32 s53, s57, 1
    s_lshl_b32 s53, s53, 4
    s_lshr_b32 s62, s57, 3
    s_add_u32 s53, s53, s62
    s_lshr_b32 s100, s53, 3
    s_lshl_b32 s100, s100, 7
    s_add_u32 s60, s60, s100
    s_and_b32 s100, s53, 7
    s_add_u32 s60, s60, s100
    s_add_u32 s22, s34, s52
    s_addc_u32 s23, s35, 0
    s_and_b32 s28, s4, 0xff
    s_mul_i32 s28, s28, 0x01010101
    s_mov_b32 s29, s28
    s_load_dwordx2 s[8:9], s[22:23], 0 glc
    s_load_dwordx2 s[10:11], s[22:23], 128 glc
    s_load_dwordx2 s[12:13], s[22:23], 256 glc
    s_load_dwordx2 s[14:15], s[22:23], 384 glc
    s_mov_b32 s55, 64
Lhint18:
    s_waitcnt lgkmcnt(0)
    s_xor_b64 s[8:9], s[8:9], s[28:29]
    s_xor_b64 s[10:11], s[10:11], s[28:29]
    s_xor_b64 s[12:13], s[12:13], s[28:29]
    s_xor_b64 s[14:15], s[14:15], s[28:29]
    s_or_b64 s[8:9], s[8:9], s[10:11]
    s_or_b64 s[12:13], s[12:13], s[14:15]
    s_or_b64 s[8:9], s[8:9], s[12:13]
    s_cbranch_scc0 Lhintd19
    s_load_dwordx2 s[8:9], s[22:23], 0 glc
    s_load_dwordx2 s[10:11], s[22:23], 128 glc
    s_load_dwordx2 s[12:13], s[22:23], 256 glc
    s_load_dwordx2 s[14:15], s[22:23], 384 glc
    s_sub_u32 s55, s55, 1
    s_cbranch_scc0 Lhint18
    s_waitcnt lgkmcnt(0)
Lhintd19:
    s_mov_b32 s55, 200000
Lqg20:
    buffer_load_dwordx4 v[48:51], v8, s[36:39], s50 offen sc1
    s_add_u32 s62, s50, 8192
    buffer_load_dwordx4 v[52:55], v8, s[36:39], s62 offen sc1
    s_add_u32 s62, s50, 16384
    buffer_load_dwordx4 v[56:59], v8, s[36:39], s62 offen sc1
    s_add_u32 s62, s50, 24576
    buffer_load_dwordx4 v[60:63], v8, s[36:39], s62 offen sc1
    s_add_u32 s62, s50, 32768
    buffer_load_dwordx4 v[64:67], v8, s[36:39], s62 offen sc1
    s_add_u32 s62, s50, 40960
    buffer_load_dwordx4 v[68:71], v8, s[36:39], s62 offen sc1
    s_add_u32 s62, s50, 49152
    buffer_load_dwordx4 v[72:75], v8, s[36:39], s62 offen sc1
    s_add_u32 s62, s50, 57344
    buffer_load_dwordx4 v[76:79], v8, s[36:39], s62 offen sc1
    s_mov_b32 exec_lo, 0x33333333
    s_mov_b32 exec_hi, 0x33333333
    buffer_load_dword v11, v10, s[36:39], s51 offen offset:1024 sc1
    s_mov_b64 exec, -1
    s_cmp_lg_u32 s55, 200000
    s_cbranch_scc1 LA_nohb
    s_barrier
LA_nohb:
    s_waitcnt vmcnt(8)
    ds_write_b128 v9, v[48:51]
    v_add3_u32 v80, v48, v49, v50
    v_add_u32 v80, v80, v51
    v_xor_b32 v2, 16, v9
    s_waitcnt vmcnt(7)
    ds_write_b128 v2, v[52:55]
    v_add3_u32 v81, v52, v53, v54
    v_add_u32 v81, v81, v55
    v_xor_b32 v2, 32, v9
    s_waitcnt vmcnt(6)
    ds_write_b128 v2, v[56:59]
    v_add3_u32 v82, v56, v57, v58
    v_add_u32 v82, v82, v59
    v_xor_b32 v2, 48, v9
    s_waitcnt vmcnt(5)
    ds_write_b128 v2, v[60:63]
    v_add3_u32 v83, v60, v61, v62
    v_add_u32 v83, v83, v63
    v_xor_b32 v2, 64, v9
    s_waitcnt vmcnt(4)
    ds_write_b128 v2, v[64:67]
    v_add3_u32 v84, v64, v65, v66
    v_add_u32 v84, v84, v67
    v_xor_b32 v2, 80, v9
    s_waitcnt vmcnt(3)
    ds_write_b128 v2, v[68:71]
    v_add3_u32 v85, v68, v69, v70
    v_add_u32 v85, v85, v71
    v_xor_b32 v2, 96, v9
    s_waitcnt vmcnt(2)
    ds_write_b128 v2, v[72:75]
    v_add3_u32 v86, v72, v73, v74
    v_add_u32 v86, v86, v75
    v_xor_b32 v2, 112, v9
    s_waitcnt vmcnt(1)
    ds_write_b128 v2, v[76:79]
    v_add3_u32 v87, v76, v77, v78
    v_add_u32 v87, v87, v79
    v_add_u32_dpp v80, v80, v80 row_ror:8 row_mask:0xf bank_mask:0x3
    v_add_u32_dpp v81, v81, v81 row_ror:8 row_mask:0xf bank_mask:0x3
    v_add_u32_dpp v82, v82, v82 row_ror:8 row_mask:0xf bank_mask:0x3
    v_add_u32_dpp v83, v83, v83 row_ror:8 row_mask:0xf bank_mask:0x3
    v_add_u32_dpp v80, v84, v84 row_ror:8 row_mask:0xf bank_mask:0xc
    v_add_u32_dpp v81, v85, v85 row_ror:8 row_mask:0xf bank_mask:0xc
    v_add_u32_dpp v82, v86, v86 row_ror:8 row_mask:0xf bank_mask:0xc
    v_add_u32_dpp v83, v87, v87 row_ror:8 row_mask:0xf bank_mask:0xc
    v_add_u32_dpp v80, v80, v80 row_half_mirror row_mask:0xf bank_mask:0x5
    v_add_u32_dpp v81, v81, v81 row_half_mirror row_mask:0xf bank_mask:0x5
    v_add_u32_dpp v80, v82, v82 row_half_mirror row_mask:0xf bank_mask:0xa
    v_add_u32_dpp v81, v83, v83 row_half_mirror row_mask:0xf bank_mask:0xa
    s_mov_b32 vcc_lo, 0xaaaaaaaa
    v_add_u32_dpp v80, v80, v80 quad_perm:[1,0,3,2] row_mask:0xf bank_mask:0xf
    v_add_u32_dpp v81, v81, v81 quad_perm:[1,0,3,2] row_mask:0xf bank_mask:0xf
    s_mov_b32 vcc_hi, 0xaaaaaaaa
    v_add_u32_dpp v80, v80, v80 quad_perm:[2,3,0,1] row_mask:0xf bank_mask:0xf
    v_add_u32_dpp v81, v81, v81 quad_perm:[2,3,0,1] row_mask:0xf bank_mask:0xf
    v_cndmask_b32 v6, v80, v81, vcc
    v_xor_b32 v6, s4, v6
    s_waitcnt vmcnt(0)
    v_cmp_ne_u32 vcc, v6, v11
    s_waitcnt lgkmcnt(0)
    s_and_b32 s62, vcc_lo, 0x33333333
    s_and_b32 s63, vcc_hi, 0x33333333
    s_or_b32 s62, s62, s63
    s_cbranch_scc0 Lqgd21
    s_sub_u32 s55, s55, 1
    s_cbranch_scc0 Lqg20
Lqgd21:
    s_barrier
    s_barrier
    s_barrier
    ds_read_b64_tr_b16 v[96:97], v18 offset:0
    ds_read_b64_tr_b16 v[98:99], v19 offset:0
    ds_read_b64_tr_b16 v[100:101], v20 offset:0
    ds_read_b64_tr_b16 v[102:103], v21 offset:0
    ds_read_b64_tr_b16 v[104:105], v22 offset:0
    ds_read_b64_tr_b16 v[106:107], v23 offset:0
    ds_read_b64_tr_b16 v[108:109], v24 offset:0
    ds_read_b64_tr_b16 v[110:111], v25 offset:0
    ds_read_b64_tr_b16 v[112:113], v18 offset:16384
    ds_read_b64_tr_b16 v[114:115], v19 offset:16384
    ds_read_b64_tr_b16 v[116:117], v20 offset:16384
    ds_read_b64_tr_b16 v[118:119], v21 offset:16384
    ds_read_b64_tr_b16 v[120:121], v22 offset:16384
    ds_read_b64_tr_b16 v[122:123], v23 offset:16384
    ds_read_b64_tr_b16 v[124:125], v24 offset:16384
    ds_read_b64_tr_b16 v[126:127], v25 offset:16384
    ds_read_b64_tr_b16 v[128:129], v18 offset:4096
    ds_read_b64_tr_b16 v[130:131], v19 offset:4096
    ds_read_b64_tr_b16 v[132:133], v20 offset:4096
    ds_read_b64_tr_b16 v[134:135], v21 offset:4096
    ds_read_b64_tr_b16 v[136:137], v22 offset:4096
    ds_read_b64_tr_b16 v[138:139], v23 offset:4096
    ds_read_b64_tr_b16 v[140:141], v24 offset:4096
    ds_read_b64_tr_b16 v[142:143], v25 offset:4096
    ds_read_b64_tr_b16 v[144:145], v18 offset:20480
    ds_read_b64_tr_b16 v[146:147], v19 offset:20480
    ds_read_b64_tr_b16 v[148:149], v20 offset:20480
    ds_read_b64_tr_b16 v[150:151], v21 offset:20480
    ds_read_b64_tr_b16 v[152:153], v22 offset:20480
    ds_read_b64_tr_b16 v[154:155], v23 offset:20480
    ds_read_b64_tr_b16 v[156:157], v24 offset:20480
    ds_read_b64_tr_b16 v[158:159], v25 offset:20480
    s_barrier
    ds_read_b64_tr_b16 v[160:161], v18 offset:8192
    ds_read_b64_tr_b16 v[162:163], v19 offset:8192
    ds_read_b64_tr_b16 v[164:165], v20 offset:8192
    ds_read_b64_tr_b16 v[166:167], v21 offset:8192
    ds_read_b64_tr_b16 v[168:169], v22 offset:8192
    ds_read_b64_tr_b16 v[170:171], v23 offset:8192
    ds_read_b64_tr_b16 v[172:173], v24 offset:8192
    ds_read_b64_tr_b16 v[174:175], v25 offset:8192
    ds_read_b64_tr_b16 v[176:177], v18 offset:24576
    ds_read_b64_tr_b16 v[178:179], v19 offset:24576
    ds_read_b64_tr_b16 v[180:181], v20 offset:24576
    ds_read_b64_tr_b16 v[182:183], v21 offset:24576
    ds_read_b64_tr_b16 v[184:185], v22 offset:24576
    ds_read_b64_tr_b16 v[186:187], v23 offset:24576
    ds_read_b64_tr_b16 v[188:189], v24 offset:24576
    ds_read_b64_tr_b16 v[190:191], v25 offset:24576
    ds_read_b64_tr_b16 v[192:193], v18 offset:12288
    ds_read_b64_tr_b16 v[194:195], v19 offset:12288
    ds_read_b64_tr_b16 v[196:197], v20 offset:12288
    ds_read_b64_tr_b16 v[198:199], v21 offset:12288
    ds_read_b64_tr_b16 v[200:201], v22 offset:12288
    ds_read_b64_tr_b16 v[202:203], v23 offset:12288
    ds_read_b64_tr_b16 v[204:205], v24 offset:12288
    ds_read_b64_tr_b16 v[206:207], v25 offset:12288
    ds_read_b64_tr_b16 v[208:209], v18 offset:28672
    ds_read_b64_tr_b16 v[210:211], v19 offset:28672
    ds_read_b64_tr_b16 v[212:213], v20 offset:28672
    ds_read_b64_tr_b16 v[214:215], v21 offset:28672
    ds_read_b64_tr_b16 v[216:217], v22 offset:28672
    ds_read_b64_tr_b16 v[218:219], v23 offset:28672
    ds_read_b64_tr_b16 v[220:221], v24 offset:28672
    ds_read_b64_tr_b16 v[222:223], v25 offset:28672
    s_cmp_lg_u32 s3, 4
    s_cbranch_scc1 Lnh22
    s_mov_b32 exec_hi, 0
    buffer_store_byte v31, v29, s[36:39], s60 offen sc1
    s_mov_b64 exec, -1
Lnh22:
    s_barrier
    ds_read_b128 v[32:35], v26 offset:0
    ds_read_b128 v[36:39], v26 offset:64
    ds_read_b128 v[40:43], v26 offset:128
    ds_read_b128 v[44:47], v26 offset:192
    ds_read_b128 v[48:51], v26 offset:4352
    ds_read_b128 v[52:55], v26 offset:4416
    ds_read_b128 v[56:59], v26 offset:4480
    ds_read_b128 v[60:63], v26 offset:4544
    s_waitcnt lgkmcnt(7)
    v_mfma_f32_16x16x32_bf16 v[64:67], v[32:35], v[96:99], 0
    v_mfma_f32_16x16x32_bf16 v[68:71], v[32:35], v[100:103], 0
    v_mfma_f32_16x16x32_bf16 v[72:75], v[32:35], v[104:107], 0
    v_mfma_f32_16x16x32_bf16 v[76:79], v[32:35], v[108:111], 0
    v_mfma_f32_16x16x32_bf16 v[80:83], v[32:35], v[112:115], 0
    v_mfma_f32_16x16x32_bf16 v[84:87], v[32:35], v[116:119], 0
    v_mfma_f32_16x16x32_bf16 v[88:91], v[32:35], v[120:123], 0
    v_mfma_f32_16x16x32_bf16 v[92:95], v[32:35], v[124:127], 0
    s_waitcnt lgkmcnt(6)
    v_mfma_f32_16x16x32_bf16 v[64:67], v[36:39], v[128:131], v[64:67]
    v_mfma_f32_16x16x32_bf16 v[68:71], v[36:39], v[132:135], v[68:71]
    v_mfma_f32_16x16x32_bf16 v[72:75], v[36:39], v[136:139], v[72:75]
    v_mfma_f32_16x16x32_bf16 v[76:79], v[36:39], v[140:143], v[76:79]
    v_mfma_f32_16x16x32_bf16 v[80:83], v[36:39], v[144:147], v[80:83]
    v_mfma_f32_16x16x32_bf16 v[84:87], v[36:39], v[148:151], v[84:87]
    v_mfma_f32_16x16x32_bf16 v[88:91], v[36:39], v[152:155], v[88:91]
    v_mfma_f32_16x16x32_bf16 v[92:95], v[36:39], v[156:159], v[92:95]
    s_waitcnt lgkmcnt(5)
    v_mfma_f32_16x16x32_bf16 v[64:67], v[40:43], v[160:163], v[64:67]
    v_mfma_f32_16x16x32_bf16 v[68:71], v[40:43], v[164:167], v[68:71]
    v_mfma_f32_16x16x32_bf16 v[72:75], v[40:43], v[168:171], v[72:75]
    v_mfma_f32_16x16x32_bf16 v[76:79], v[40:43], v[172:175], v[76:79]
    v_mfma_f32_16x16x32_bf16 v[80:83], v[40:43], v[176:179], v[80:83]
    v_mfma_f32_16x16x32_bf16 v[84:87], v[40:43], v[180:183], v[84:87]
    v_mfma_f32_16x16x32_bf16 v[88:91], v[40:43], v[184:187], v[88:91]
    v_mfma_f32_16x16x32_bf16 v[92:95], v[40:43], v[188:191], v[92:95]
    s_waitcnt lgkmcnt(4)
    v_mfma_f32_16x16x32_bf16 v[64:67], v[44:47], v[192:195], v[64:67]
    v_mfma_f32_16x16x32_bf16 v[68:71], v[44:47], v[196:199], v[68:71]
    v_mfma_f32_16x16x32_bf16 v[72:75], v[44:47], v[200:203], v[72:75]
    v_mfma_f32_16x16x32_bf16 v[76:79], v[44:47], v[204:207], v[76:79]
    v_mfma_f32_16x16x32_bf16 v[80:83], v[44:47], v[208:211], v[80:83]
    v_mfma_f32_16x16x32_bf16 v[84:87], v[44:47], v[212:215], v[84:87]
    v_mfma_f32_16x16x32_bf16 v[88:91], v[44:47], v[216:219], v[88:91]
    v_mfma_f32_16x16x32_bf16 v[92:95], v[44:47], v[220:223], v[92:95]
    s_waitcnt lgkmcnt(0)
    v_mfma_f32_16x16x32_bf16 v[224:227], v[48:51], v[96:99], 0
    v_mfma_f32_16x16x32_bf16 v[228:231], v[48:51], v[100:103], 0
    v_mfma_f32_16x16x32_bf16 v[232:235], v[48:51], v[104:107], 0
    v_mfma_f32_16x16x32_bf16 v[236:239], v[48:51], v[108:111], 0
    v_mfma_f32_16x16x32_bf16 v[240:243], v[48:51], v[112:115], 0
    v_cvt_pk_bf16_f32 v2, v64, v68
    v_mfma_f32_16x16x32_bf16 v[244:247], v[48:51], v[116:119], 0
    v_cvt_pk_bf16_f32 v3, v72, v76
    v_mfma_f32_16x16x32_bf16 v[248:251], v[48:51], v[120:123], 0
    v_cvt_pk_bf16_f32 v4, v80, v84
    v_mfma_f32_16x16x32_bf16 v[252:255], v[48:51], v[124:127], 0
    v_cvt_pk_bf16_f32 v5, v88, v92
    v_mfma_f32_16x16x32_bf16 v[224:227], v[52:55], v[128:131], v[224:227]
    buffer_store_dwordx4 v[2:5], v27, s[36:39], s59 offen offset:0 sc1
    v_mfma_f32_16x16x32_bf16 v[228:231], v[52:55], v[132:135], v[228:231]
    v_cvt_pk_bf16_f32 v6, v65, v69
    v_mfma_f32_16x16x32_bf16 v[232:235], v[52:55], v[136:139], v[232:235]
    v_cvt_pk_bf16_f32 v7, v73, v77
    v_mfma_f32_16x16x32_bf16 v[236:239], v[52:55], v[140:143], v[236:239]
    v_cvt_pk_bf16_f32 v8, v81, v85
    v_mfma_f32_16x16x32_bf16 v[240:243], v[52:55], v[144:147], v[240:243]
    v_cvt_pk_bf16_f32 v9, v89, v93
    v_mfma_f32_16x16x32_bf16 v[244:247], v[52:55], v[148:151], v[244:247]
    buffer_store_dwordx4 v[6:9], v27, s[36:39], s59 offen offset:1024 sc1
    v_mfma_f32_16x16x32_bf16 v[248:251], v[52:55], v[152:155], v[248:251]
    v_cvt_pk_bf16_f32 v10, v66, v70
    v_mfma_f32_16x16x32_bf16 v[252:255], v[52:55], v[156:159], v[252:255]
    v_cvt_pk_bf16_f32 v11, v74, v78
    v_mfma_f32_16x16x32_bf16 v[224:227], v[56:59], v[160:163], v[224:227]
    v_cvt_pk_bf16_f32 v12, v82, v86
    v_mfma_f32_16x16x32_bf16 v[228:231], v[56:59], v[164:167], v[228:231]
    v_cvt_pk_bf16_f32 v13, v90, v94
    v_mfma_f32_16x16x32_bf16 v[232:235], v[56:59], v[168:171], v[232:235]
    buffer_store_dwordx4 v[10:13], v27, s[36:39], s59 offen offset:2048 sc1
    v_mfma_f32_16x16x32_bf16 v[236:239], v[56:59], v[172:175], v[236:239]
    v_cvt_pk_bf16_f32 v14, v67, v71
    v_mfma_f32_16x16x32_bf16 v[240:243], v[56:59], v[176:179], v[240:243]
    v_cvt_pk_bf16_f32 v15, v75, v79
    v_mfma_f32_16x16x32_bf16 v[244:247], v[56:59], v[180:183], v[244:247]
    v_cvt_pk_bf16_f32 v16, v83, v87
    v_mfma_f32_16x16x32_bf16 v[248:251], v[56:59], v[184:187], v[248:251]
    v_cvt_pk_bf16_f32 v17, v91, v95
    v_mfma_f32_16x16x32_bf16 v[252:255], v[56:59], v[188:191], v[252:255]
    buffer_store_dwordx4 v[14:17], v27, s[36:39], s59 offen offset:3072 sc1
    v_mfma_f32_16x16x32_bf16 v[224:227], v[60:63], v[192:195], v[224:227]
    v_add3_u32 v18, v2, v3, v4
    v_mfma_f32_16x16x32_bf16 v[228:231], v[60:63], v[196:199], v[228:231]
    v_add_u32 v18, v18, v5
    v_mfma_f32_16x16x32_bf16 v[232:235], v[60:63], v[200:203], v[232:235]
    v_add3_u32 v19, v6, v7, v8
    v_mfma_f32_16x16x32_bf16 v[236:239], v[60:63], v[204:207], v[236:239]
    v_add_u32 v19, v19, v9
    v_mfma_f32_16x16x32_bf16 v[240:243], v[60:63], v[208:211], v[240:243]
    v_add3_u32 v20, v10, v11, v12
    v_mfma_f32_16x16x32_bf16 v[244:247], v[60:63], v[212:215], v[244:247]
    v_add_u32 v20, v20, v13
    v_mfma_f32_16x16x32_bf16 v[248:251], v[60:63], v[216:219], v[248:251]
    v_add3_u32 v21, v14, v15, v16
    v_mfma_f32_16x16x32_bf16 v[252:255], v[60:63], v[220:223], v[252:255]
    v_add_u32 v21, v21, v17
    s_nop 3
    v_cvt_pk_bf16_f32 v2, v224, v228
    v_cvt_pk_bf16_f32 v3, v232, v236
    v_cvt_pk_bf16_f32 v4, v240, v244
    v_cvt_pk_bf16_f32 v5, v248, v252
    buffer_store_dwordx4 v[2:5], v27, s[36:39], s56 offen offset:0 sc1
    v_cvt_pk_bf16_f32 v6, v225, v229
    v_cvt_pk_bf16_f32 v7, v233, v237
    v_cvt_pk_bf16_f32 v8, v241, v245
    v_cvt_pk_bf16_f32 v9, v249, v253
    buffer_store_dwordx4 v[6:9], v27, s[36:39], s56 offen offset:1024 sc1
    v_cvt_pk_bf16_f32 v10, v226, v230
    v_cvt_pk_bf16_f32 v11, v234, v238
    v_cvt_pk_bf16_f32 v12, v242, v246
    v_cvt_pk_bf16_f32 v13, v250, v254
    buffer_store_dwordx4 v[10:13], v27, s[36:39], s56 offen offset:2048 sc1
    v_cvt_pk_bf16_f32 v14, v227, v231
    v_cvt_pk_bf16_f32 v15, v235, v239
    v_cvt_pk_bf16_f32 v16, v243, v247
    v_cvt_pk_bf16_f32 v17, v251, v255
    buffer_store_dwordx4 v[14:17], v27, s[36:39], s56 offen offset:3072 sc1
    v_add3_u32 v22, v2, v3, v4
    v_add_u32 v22, v22, v5
    v_add3_u32 v23, v6, v7, v8
    v_add_u32 v23, v23, v9
    v_add3_u32 v24, v10, v11, v12
    v_add_u32 v24, v24, v13
    v_add3_u32 v25, v14, v15, v16
    v_add_u32 v25, v25, v17
    v_add_u32_dpp v18, v18, v18 row_ror:8 row_mask:0xf bank_mask:0x3
    v_add_u32_dpp v19, v19, v19 row_ror:8 row_mask:0xf bank_mask:0x3
    v_add_u32_dpp v20, v20, v20 row_ror:8 row_mask:0xf bank_mask:0x3
    v_add_u32_dpp v21, v21, v21 row_ror:8 row_mask:0xf bank_mask:0x3
    v_add_u32_dpp v18, v22, v22 row_ror:8 row_mask:0xf bank_mask:0xc
    v_add_u32_dpp v19, v23, v23 row_ror:8 row_mask:0xf bank_mask:0xc
    v_add_u32_dpp v20, v24, v24 row_ror:8 row_mask:0xf bank_mask:0xc
    v_add_u32_dpp v21, v25, v25 row_ror:8 row_mask:0xf bank_mask:0xc
    v_add_u32_dpp v18, v18, v18 row_half_mirror row_mask:0xf bank_mask:0x5
    v_add_u32_dpp v19, v19, v19 row_half_mirror row_mask:0xf bank_mask:0x5
    v_add_u32_dpp v18, v20, v20 row_half_mirror row_mask:0xf bank_mask:0xa
    v_add_u32_dpp v19, v21, v21 row_half_mirror row_mask:0xf bank_mask:0xa
    s_mov_b32 vcc_lo, 0xaaaaaaaa
    v_add_u32_dpp v18, v18, v18 quad_perm:[1,0,3,2] row_mask:0xf bank_mask:0xf
    v_add_u32_dpp v19, v19, v19 quad_perm:[1,0,3,2] row_mask:0xf bank_mask:0xf
    s_mov_b32 vcc_hi, 0xaaaaaaaa
    v_add_u32_dpp v18, v18, v18 quad_perm:[2,3,0,1] row_mask:0xf bank_mask:0xf
    v_add_u32_dpp v19, v19, v19 quad_perm:[2,3,0,1] row_mask:0xf bank_mask:0xf
    v_cndmask_b32 v32, v18, v19, vcc
    v_xor_b32 v32, s4, v32
    s_mov_b32 exec_lo, 0x33333333
    s_mov_b32 exec_hi, 0x33333333
    buffer_store_dword v32, v28, s[36:39], s61 offen offset:512 sc1
    s_mov_b64 exec, -1
    s_barrier
    s_cmp_lg_u32 s3, 7
    s_cbranch_scc1 LA_end
    s_and_b32 s62, s57, 7
    s_lshl_b32 s62, s62, 4
    s_lshr_b32 s57, s57, 3
    s_add_u32 s57, s57, s62
    s_lshr_b32 s6, s57, 5
    s_and_b32 s5, s57, 31
    s_lshl_b32 s50, s6, 17
    s_lshl_b32 s62, s5, 7
    s_add_u32 s50, s50, s62
    s_add_u32 s50, s50, 1048576
    s_add_u32 s51, s50, 0x8000
    s_add_u32 s53, s50, 0x10000
    s_add_u32 s54, s50, 0x18000
    v_lshrrev_b32 v2, 3, v1
    v_and_b32 v3, 7, v1
    v_lshlrev_b32 v3, 4, v3
    v_lshl_add_u32 v34, v2, 12, v3
    v_and_b32 v2, 3, v1
    v_lshlrev_b32 v2, 10, v2
    v_and_b32 v3, 4, v1
    v_add_u32 v2, v2, v3
    s_lshl_b32 s62, s57, 3
    v_add_u32 v35, s62, v2
    s_and_b32 s52, s57, 103
    s_lshl_b32 s52, s52, 10
    s_add_u32 s52, s52, 7995392
    s_add_u32 s22, s34, s52
    s_addc_u32 s23, s35, 0
    s_and_b32 s28, s4, 0xff
    s_mul_i32 s28, s28, 0x01010101
    s_mov_b32 s29, s28
    s_load_dwordx2 s[8:9], s[22:23], 0 glc
    s_load_dwordx2 s[10:11], s[22:23], 128 glc
    s_load_dwordx2 s[12:13], s[22:23], 256 glc
    s_load_dwordx2 s[14:15], s[22:23], 384 glc
    s_mov_b32 s55, 64
Lhint23:
    s_waitcnt lgkmcnt(0)
    s_xor_b64 s[8:9], s[8:9], s[28:29]
    s_xor_b64 s[10:11], s[10:11], s[28:29]
    s_xor_b64 s[12:13], s[12:13], s[28:29]
    s_xor_b64 s[14:15], s[14:15], s[28:29]
    s_or_b64 s[8:9], s[8:9], s[10:11]
    s_or_b64 s[12:13], s[12:13], s[14:15]
    s_or_b64 s[8:9], s[8:9], s[12:13]
    s_cbranch_scc0 Lhintd24
    s_load_dwordx2 s[8:9], s[22:23], 0 glc
    s_load_dwordx2 s[10:11], s[22:23], 128 glc
    s_load_dwordx2 s[12:13], s[22:23], 256 glc
    s_load_dwordx2 s[14:15], s[22:23], 384 glc
    s_sub_u32 s55, s55, 1
    s_cbranch_scc0 Lhint23
    s_waitcnt lgkmcnt(0)
Lhintd24:
    s_mov_b32 s55, 199999
Lpoll25:
    buffer_load_dwordx4 v[48:51], v34, s[36:39], s50 offen offset:0 sc1
    buffer_load_dwordx4 v[52:55], v34, s[36:39], s51 offen offset:0 sc1
    buffer_load_dwordx4 v[56:59], v34, s[36:39], s53 offen offset:0 sc1
    buffer_load_dwordx4 v[60:63], v34, s[36:39], s54 offen offset:0 sc1
    s_waitcnt vmcnt(0)
    v_xor_b32 v2, s4, v49
    v_xor_b32 v3, s4, v51
    v_xor_b32 v4, s4, v53
    v_xor_b32 v5, s4, v55
    v_or3_b32 v2, v2, v4, v5
    v_xor_b32 v4, s4, v57
    v_xor_b32 v5, s4, v59
    v_or3_b32 v2, v2, v4, v5
    v_xor_b32 v4, s4, v61
    v_xor_b32 v5, s4, v63
    v_or3_b32 v2, v2, v4, v5
    v_or_b32 v2, v2, v3
    v_cmp_ne_u32 vcc, 0, v2
    s_cbranch_vccz Ldone26
    s_sub_u32 s55, s55, 1
    s_cbranch_scc0 Lpoll25
Ldone26:
    v_add_f32 v48, v48, v52
    v_add_f32 v50, v50, v54
    v_add_f32 v56, v56, v60
    v_add_f32 v58, v58, v62
    v_add_f32 v32, v48, v56
    v_add_f32 v33, v50, v58
    s_nop 1
    v_add_f32_dpp v32, v32, v32 row_ror:8 row_mask:0xf bank_mask:0xf
    v_add_f32_dpp v33, v33, v33 row_ror:8 row_mask:0xf bank_mask:0xf
    v_mov_b32 v2, v32
    v_mov_b32 v3, v33
    s_nop 1
    v_permlane16_swap_b32 v32, v2
    v_permlane16_swap_b32 v33, v3
    s_nop 1
    v_add_f32 v32, v32, v2
    v_add_f32 v33, v33, v3
    v_mov_b32 v2, v32
    v_mov_b32 v3, v33
    s_nop 1
    v_permlane32_swap_b32 v32, v2
    v_permlane32_swap_b32 v33, v3
    s_nop 1
    v_add_f32 v32, v32, v2
    v_add_f32 v33, v33, v3
    v_cvt_pk_bf16_f32 v32, v32, v33
    s_mov_b64 exec, 0xff
    global_store_dword v35, v32, s[30:31]
    s_mov_b64 exec, -1
LA_end:
Lend:
    s_endpgm
Lcode_end:
.set CODE_BYTES, Lcode_end-gated_mix__compressed_kv_cla__swiglu_ffn__decode_kernel
.section .rodata,"a"
.p2align 6
.amdhsa_kernel gated_mix__compressed_kv_cla__swiglu_ffn__decode_kernel
  .amdhsa_next_free_vgpr 256
  .amdhsa_next_free_sgpr 102
  .amdhsa_accum_offset 256
  .amdhsa_group_segment_fixed_size 0
  .amdhsa_kernarg_size 112
  .amdhsa_user_sgpr_count 2
  .amdhsa_user_sgpr_kernarg_segment_ptr 1
  .amdhsa_system_sgpr_workgroup_id_x 1
.end_amdhsa_kernel
```
